```python
import torch

def _softmax(x, axis=-1):
    return torch.softmax(x, dim=axis)
def _gelu(x):
    return torch.nn.functional.gelu(x, approximate="tanh")
def _silu(x):
    return torch.nn.functional.silu(x)
def _sigmoid(x):
    return torch.sigmoid(x)
def _layernorm(x, axis=-1, eps=1e-5):
    m = x.mean(dim=axis, keepdim=True)
    v = x.var(dim=axis, keepdim=True, unbiased=False)
    return (x - m) / torch.sqrt(v + eps)
def _scatter_add(tgt, idx, src, axis=0):
    return tgt.clone().index_add_(axis, idx, src)
def _segment_sum(src, seg, n):
    out = torch.zeros((n,) + src.shape[1:], dtype=src.dtype)
    return out.index_add_(0, seg, src)
def _pad(x, pw):
    flat = tuple(v for pair in reversed(pw) for v in pair)
    return torch.nn.functional.pad(x, flat)

kernel_name = 'sequential_preLN__sliding_block_cached__mixer_token_mlp__decode'

def setup_inputs():

    _w = (lambda a: (lambda t: t.to(torch.bfloat16) if t.is_floating_point() else t)(torch.as_tensor(a)))
    def _A_setup():
        B, Sq, D = 1, 1, 640
        Hq, Hkv, Sk, Dh = 32, 32, 16384, 192
        assert Hq % Hkv == 0, (Hq, Hkv)
        return {
            "x": _w((lambda *s: torch.randn(*s, dtype=torch.bfloat16) * 0.2)(B, Sq, D)),
            "k_cache": _w((lambda *s: torch.randn(*s, dtype=torch.bfloat16) * 1.6)(B, Hkv, Sk, Dh)),
            "v_cache": _w((lambda *s: torch.randn(*s, dtype=torch.bfloat16) * 3.2)(B, Hkv, Sk, Dh)),
            "wq": _w((lambda *s: torch.randn(*s, dtype=torch.bfloat16) * 1.6)(D, Hq * Dh) * (D ** -0.5)),
            "wo": _w((lambda *s: torch.randn(*s, dtype=torch.bfloat16) * 3.2)(Hq * Dh, D) * ((Hq * Dh) ** -0.5)),
        }
    _A_in = _A_setup()

    def _B_setup():
        B, S, D, F = 1, 1, 640, 1536
        return {
            "x": _w((lambda *s: torch.randn(*s, dtype=torch.bfloat16) * 0.2)(B, S, D)),
            "w1": _w((lambda *s: torch.randn(*s, dtype=torch.bfloat16) * 3.2)(S, F) * (S ** -0.5)),
            "b1": _w((lambda *s: torch.randn(*s, dtype=torch.bfloat16) * 3.2)(F) * 0.02),
            "w2": _w((lambda *s: torch.randn(*s, dtype=torch.bfloat16) * 3.2)(F, S) * (F ** -0.5)),
            "b2": _w((lambda *s: torch.randn(*s, dtype=torch.bfloat16) * 3.2)(S) * 0.02),
        }
    _B_in = _B_setup()

    return {
        "A_x": _A_in["x"],
        "A_k_cache": _A_in["k_cache"],
        "A_v_cache": _A_in["v_cache"],
        "A_wq": _A_in["wq"],
        "A_wo": _A_in["wo"],
        "B_x": _B_in["x"],
        "B_w1": _B_in["w1"],
        "B_b1": _B_in["b1"],
        "B_w2": _B_in["w2"],
        "B_b2": _B_in["b2"],
    }

def reference(A_x, A_k_cache, A_v_cache, A_wq, A_wo, B_x, B_w1, B_b1, B_w2, B_b2):
    def _A_ref(x, k_cache, v_cache, wq, wo):
        B, Sq, D = x.shape
        Hq, Dh = 32, 192
        Hkv, Sk = k_cache.shape[1], k_cache.shape[2]
        W = min(4096, max(256, Sk // 4))
        rep = Hq // Hkv
        q = (lambda x, *d: x.permute(*d))((x @ wq).reshape(B, Sq, Hq, Dh), 0, 2, 1, 3)
        k = (lambda x, n, axis: torch.repeat_interleave(x, n, dim=axis))(k_cache[:, :, Sk - W:, :], rep, axis=1)
        v = (lambda x, n, axis: torch.repeat_interleave(x, n, dim=axis))(v_cache[:, :, Sk - W:, :], rep, axis=1)
        scores = torch.einsum("bhqd,bhkd->bhqk", q, k) * (Dh ** -0.5)
        p = _softmax(scores, axis=-1)
        o = torch.einsum("bhqk,bhkd->bhqd", p, v)
        return (lambda x, *d: x.permute(*d))(o, 0, 2, 1, 3).reshape(B, Sq, Hq * Dh) @ wo

    def _B_ref(x, w1, b1, w2, b2):
        B, S, D = x.shape
        h = _layernorm(x, axis=-1)
        u = torch.einsum("bsd,sf->bdf", h, w1) + b1
        u = _gelu(u)
        y = torch.einsum("bdf,fs->bds", u, w2) + b2
        return (lambda x, *d: x.permute(*d))(y, 0, 2, 1)

    x = A_x
    h = x + _A_ref(_layernorm(x, axis=-1), A_k_cache, A_v_cache, A_wq, A_wo)
    h2 = h + _B_ref(_layernorm(h, axis=-1), B_w1, B_b1, B_w2, B_b2)
    return h2
```

```asm
; @launch grid=(256,1,1) block=(576,1,1) lds=32768
.amdgcn_target "amdgcn-amd-amdhsa--gfx950"
.text
.globl sequential_preLN__sliding_block_cached__mixer_token_mlp__decode_kernel
.p2align 8
.type sequential_preLN__sliding_block_cached__mixer_token_mlp__decode_kernel,@function
sequential_preLN__sliding_block_cached__mixer_token_mlp__decode_kernel:
    s_cmp_ge_u32 s2, 0x100
    s_cbranch_scc1 L_end
    s_load_dwordx16 s[16:31], s[0:1], 0
    s_load_dwordx8 s[32:39], s[0:1], 64
    s_load_dwordx2 s[40:41], s[0:1], 96
    v_and_b32 v1, 63, v0
    v_lshrrev_b32 v3, 6, v0
    s_nop 0
    v_readfirstlane_b32 s3, v3
    s_lshr_b32 s12, s2, 3
    s_and_b32 s13, s2, 7
    s_mul_i32 s14, s2, 205
    s_lshr_b32 s14, s14, 11
    s_mul_i32 s15, s14, 10
    s_sub_u32 s15, s2, s15
    s_mov_b32 s4, s3
    s_add_u32 s11, s4, 7
    s_and_b32 s11, s11, 7
    s_mul_i32 s11, s11, 3072
    s_add_u32 s10, s4, 6
    s_and_b32 s10, s10, 7
    s_mul_i32 s10, s10, 3072
    s_add_u32 s9, s4, 5
    s_and_b32 s9, s9, 7
    s_mul_i32 s9, s9, 3072
    s_add_u32 s8, s4, 4
    s_and_b32 s8, s8, 7
    s_mul_i32 s8, s8, 3072
    s_add_u32 s7, s4, 3
    s_and_b32 s7, s7, 7
    s_mul_i32 s7, s7, 3072
    s_add_u32 s6, s4, 2
    s_and_b32 s6, s6, 7
    s_mul_i32 s6, s6, 3072
    s_add_u32 s5, s4, 1
    s_and_b32 s5, s5, 7
    s_mul_i32 s5, s5, 3072
    s_add_u32 s4, s4, 0
    s_and_b32 s4, s4, 7
    s_mul_i32 s4, s4, 3072
    s_mul_i32 s94, s12, 6291456
    s_mul_i32 s95, s13, 196608
    s_add_u32 s94, s94, s95
    s_add_u32 s94, s94, 4718592
    s_mul_i32 s95, s13, 983040
    s_mul_i32 s96, s12, 384
    s_add_u32 s95, s95, s96
    s_mov_b32 s47, 0x00020000
    s_mov_b32 s51, 0x00020000
    s_mov_b32 s55, 0x00020000
    s_mov_b32 s59, 0x00020000
    s_mov_b32 s63, 0x00020000
    s_mov_b32 s67, 0x00020000
    s_mov_b32 s71, 0x00020000
    s_mov_b32 s75, 0x00020000
    s_mov_b32 s79, 0x00020000
    s_mov_b32 s83, 0x00020000
    s_mov_b32 s87, 0x00020000
    s_mov_b32 s46, 1280
    s_mov_b32 s50, 196608
    s_mov_b32 s54, 196608
    s_mov_b32 s58, 971136
    s_mov_b32 s62, 326528
    s_mov_b32 s66, 1048576
    s_mov_b32 s70, 3072
    s_mov_b32 s74, 3072
    s_mov_b32 s78, 3072
    s_mov_b32 s82, 1280
    s_mov_b32 s86, 2
    s_waitcnt lgkmcnt(0)
    s_load_dword s92, s[40:41], 0
    s_mov_b64 s[44:45], s[16:17]
    s_add_u32 s56, s22, s95
    s_addc_u32 s57, s23, 0
    s_add_u32 s48, s18, s94
    s_addc_u32 s49, s19, 0
    s_add_u32 s52, s20, s94
    s_addc_u32 s53, s21, 0
    s_min_u32 s94, s14, 23
    s_mul_i32 s94, s94, 327680
    s_lshl_b32 s95, s15, 7
    s_add_u32 s94, s94, s95
    s_add_u32 s60, s24, s94
    s_addc_u32 s61, s25, 0
    s_mov_b64 s[64:65], s[40:41]
    s_mov_b64 s[68:69], s[28:29]
    s_mov_b64 s[72:73], s[30:31]
    s_mov_b64 s[76:77], s[32:33]
    s_mov_b64 s[80:81], s[36:37]
    s_mov_b64 s[84:85], s[34:35]
    s_cmp_eq_u32 s3, 8
    s_cbranch_scc1 L_comm
    v_lshlrev_b32 v4, 4, v1
    v_lshlrev_b32 v5, 2, v1
    buffer_load_dwordx4 v[132:135], v4, s[44:47], 0 offen
    buffer_load_dword v136, v5, s[44:47], 0 offen offset:1024
    v_mul_u32_u24 v3, 2731, v0
    v_lshrrev_b32 v3, 16, v3
    v_mul_u32_u24 v4, 24, v3
    v_sub_u32 v4, v0, v4
    s_mul_i32 s94, s13, 160
    v_lshlrev_b32 v6, 1, v3
    buffer_load_ushort v137, v6, s[44:47], s94 offen offset:0
    buffer_load_ushort v138, v6, s[44:47], s94 offen offset:40
    buffer_load_ushort v139, v6, s[44:47], s94 offen offset:80
    buffer_load_ushort v140, v6, s[44:47], s94 offen offset:120
    v_mul_u32_u24 v7, 12288, v3
    v_lshl_add_u32 v7, v4, 4, v7
    v_mov_b32 v5, 0x80000000
    v_cmp_gt_u32 vcc, 480, v0
    s_mov_b32 s94, 245760
    s_mov_b32 s95, 491520
    s_mov_b32 s96, 737280
    v_cndmask_b32 v7, v5, v7, vcc
    buffer_load_dwordx4 v[104:107], v7, s[56:59], 0 offen nt
    buffer_load_dwordx4 v[108:111], v7, s[56:59], s94 offen nt
    buffer_load_dwordx4 v[112:115], v7, s[56:59], s95 offen nt
    buffer_load_dwordx4 v[116:119], v7, s[56:59], s96 offen nt
    v_lshrrev_b32 v2, 3, v1
    v_mul_u32_u24 v2, 384, v2
    v_and_b32 v3, 7, v1
    v_lshl_add_u32 v2, v3, 4, v2
    s_mul_i32 s94, s3, 24576
    v_add_u32 v2, s94, v2
    s_barrier
    buffer_load_dwordx4 v[8:11], v2, s[48:51], s4 offen offset:0 nt
    buffer_load_dwordx4 v[12:15], v2, s[48:51], s4 offen offset:128 nt
    buffer_load_dwordx4 v[16:19], v2, s[48:51], s4 offen offset:256 nt
    s_waitcnt vmcnt(7)
    v_mov_b32 v3, 0x3f803f80
    v_dot2_f32_bf16 v142, v132, v3, 0
    v_dot2_f32_bf16 v143, v132, v132, 0
    v_dot2_f32_bf16 v142, v133, v3, v142
    v_dot2_f32_bf16 v143, v133, v133, v143
    v_dot2_f32_bf16 v142, v134, v3, v142
    v_dot2_f32_bf16 v143, v134, v134, v143
    v_dot2_f32_bf16 v142, v135, v3, v142
    v_dot2_f32_bf16 v143, v135, v135, v143
    v_dot2_f32_bf16 v142, v136, v3, v142
    v_dot2_f32_bf16 v143, v136, v136, v143
    v_lshlrev_b32 v137, 16, v137
    v_lshlrev_b32 v138, 16, v138
    v_lshlrev_b32 v139, 16, v139
    v_lshlrev_b32 v140, 16, v140
    v_add_f32_dpp v142, v142, v142 quad_perm:[1,0,3,2] row_mask:0xf bank_mask:0xf
    v_add_f32_dpp v143, v143, v143 quad_perm:[1,0,3,2] row_mask:0xf bank_mask:0xf
    s_nop 0
    v_add_f32_dpp v142, v142, v142 quad_perm:[2,3,0,1] row_mask:0xf bank_mask:0xf
    v_add_f32_dpp v143, v143, v143 quad_perm:[2,3,0,1] row_mask:0xf bank_mask:0xf
    s_nop 0
    v_add_f32_dpp v142, v142, v142 row_half_mirror row_mask:0xf bank_mask:0xf
    v_add_f32_dpp v143, v143, v143 row_half_mirror row_mask:0xf bank_mask:0xf
    s_nop 0
    v_add_f32_dpp v142, v142, v142 row_ror:8 row_mask:0xf bank_mask:0xf
    v_add_f32_dpp v143, v143, v143 row_ror:8 row_mask:0xf bank_mask:0xf
    v_mov_b32 v164, v142
    v_mov_b32 v165, v143
    s_nop 0
    v_permlane16_swap_b32 v142, v164
    v_permlane16_swap_b32 v143, v165
    v_add_f32 v142, v142, v164
    v_add_f32 v143, v143, v165
    v_mov_b32 v164, v142
    v_mov_b32 v165, v143
    s_nop 0
    v_permlane32_swap_b32 v142, v164
    v_permlane32_swap_b32 v143, v165
    v_add_f32 v142, v142, v164
    v_add_f32 v143, v143, v165
    v_mul_f32 v142, 0x3acccccd, v142
    v_mul_f32 v143, 0x3acccccd, v143
    v_fma_f32 v143, -v142, v142, v143
    v_max_f32 v143, 0, v143
    v_cvt_pk_bf16_f32 v143, 0, v143
    v_add_f32 v143, 0x3727c5ac, v143
    v_cvt_pk_bf16_f32 v143, 0, v143
    v_sqrt_f32 v143, v143
    v_cvt_pk_bf16_f32 v142, 0, v142
    v_cvt_pk_bf16_f32 v143, 0, v143
    v_rcp_f32 v143, v143
    v_sub_f32 v137, v137, v142
    v_sub_f32 v138, v138, v142
    v_sub_f32 v139, v139, v142
    v_sub_f32 v140, v140, v142
    v_cvt_pk_bf16_f32 v137, 0, v137
    v_cvt_pk_bf16_f32 v138, 0, v138
    v_cvt_pk_bf16_f32 v139, 0, v139
    v_cvt_pk_bf16_f32 v140, 0, v140
    v_mul_f32 v137, v137, v143
    v_mul_f32 v138, v138, v143
    v_mul_f32 v139, v139, v143
    v_mul_f32 v140, v140, v143
    v_cvt_pk_bf16_f32 v156, v137, 0
    v_cvt_pk_bf16_f32 v160, 0, v137
    v_cvt_pk_bf16_f32 v157, v138, 0
    v_cvt_pk_bf16_f32 v161, 0, v138
    v_cvt_pk_bf16_f32 v158, v139, 0
    v_cvt_pk_bf16_f32 v162, 0, v139
    v_cvt_pk_bf16_f32 v159, v140, 0
    v_cvt_pk_bf16_f32 v163, 0, v140
    s_waitcnt vmcnt(6)
    v_dot2_f32_bf16 v144, v104, v156, 0
    v_dot2_f32_bf16 v145, v104, v160, 0
    v_dot2_f32_bf16 v146, v105, v156, 0
    v_dot2_f32_bf16 v147, v105, v160, 0
    v_dot2_f32_bf16 v148, v106, v156, 0
    v_dot2_f32_bf16 v149, v106, v160, 0
    v_dot2_f32_bf16 v150, v107, v156, 0
    v_dot2_f32_bf16 v151, v107, v160, 0
    s_waitcnt vmcnt(5)
    v_dot2_f32_bf16 v144, v108, v157, v144
    v_dot2_f32_bf16 v145, v108, v161, v145
    v_dot2_f32_bf16 v146, v109, v157, v146
    v_dot2_f32_bf16 v147, v109, v161, v147
    v_dot2_f32_bf16 v148, v110, v157, v148
    v_dot2_f32_bf16 v149, v110, v161, v149
    v_dot2_f32_bf16 v150, v111, v157, v150
    v_dot2_f32_bf16 v151, v111, v161, v151
    s_waitcnt vmcnt(4)
    v_dot2_f32_bf16 v144, v112, v158, v144
    v_dot2_f32_bf16 v145, v112, v162, v145
    v_dot2_f32_bf16 v146, v113, v158, v146
    v_dot2_f32_bf16 v147, v113, v162, v147
    v_dot2_f32_bf16 v148, v114, v158, v148
    v_dot2_f32_bf16 v149, v114, v162, v149
    v_dot2_f32_bf16 v150, v115, v158, v150
    v_dot2_f32_bf16 v151, v115, v162, v151
    s_waitcnt vmcnt(3)
    v_dot2_f32_bf16 v144, v116, v159, v144
    v_dot2_f32_bf16 v145, v116, v163, v145
    v_dot2_f32_bf16 v146, v117, v159, v146
    v_dot2_f32_bf16 v147, v117, v163, v147
    v_dot2_f32_bf16 v148, v118, v159, v148
    v_dot2_f32_bf16 v149, v118, v163, v149
    v_dot2_f32_bf16 v150, v119, v159, v150
    v_dot2_f32_bf16 v151, v119, v163, v151
    v_lshlrev_b32 v3, 5, v0
    ds_write_b128 v3, v[144:147] offset:0
    s_nop 0
    ds_write_b128 v3, v[148:151] offset:16
    s_waitcnt lgkmcnt(0)
    s_barrier
    buffer_load_dwordx4 v[20:23], v2, s[48:51], s5 offen offset:0 nt
    s_waitcnt vmcnt(3)
    buffer_load_dwordx4 v[24:27], v2, s[48:51], s5 offen offset:128 nt
    s_waitcnt vmcnt(3)
    buffer_load_dwordx4 v[28:31], v2, s[48:51], s5 offen offset:256 nt
    s_waitcnt vmcnt(3)
    buffer_load_dwordx4 v[32:35], v2, s[48:51], s6 offen offset:0 nt
    s_waitcnt vmcnt(3)
    buffer_load_dwordx4 v[36:39], v2, s[48:51], s6 offen offset:128 nt
    s_waitcnt vmcnt(3)
    buffer_load_dwordx4 v[40:43], v2, s[48:51], s6 offen offset:256 nt
    s_waitcnt vmcnt(3)
    buffer_load_dwordx4 v[44:47], v2, s[48:51], s7 offen offset:0 nt
    s_waitcnt vmcnt(3)
    buffer_load_dwordx4 v[48:51], v2, s[48:51], s7 offen offset:128 nt
    s_waitcnt vmcnt(3)
    buffer_load_dwordx4 v[52:55], v2, s[48:51], s7 offen offset:256 nt
    s_waitcnt vmcnt(3)
    buffer_load_dwordx4 v[56:59], v2, s[48:51], s8 offen offset:0 nt
    s_waitcnt vmcnt(3)
    buffer_load_dwordx4 v[60:63], v2, s[48:51], s8 offen offset:128 nt
    s_waitcnt vmcnt(3)
    buffer_load_dwordx4 v[64:67], v2, s[48:51], s8 offen offset:256 nt
    s_waitcnt vmcnt(3)
    buffer_load_dwordx4 v[68:71], v2, s[48:51], s9 offen offset:0 nt
    s_waitcnt vmcnt(3)
    buffer_load_dwordx4 v[72:75], v2, s[48:51], s9 offen offset:128 nt
    s_waitcnt vmcnt(3)
    buffer_load_dwordx4 v[76:79], v2, s[48:51], s9 offen offset:256 nt
    s_waitcnt vmcnt(3)
    buffer_load_dwordx4 v[80:83], v2, s[48:51], s10 offen offset:0 nt
    s_waitcnt vmcnt(3)
    buffer_load_dwordx4 v[84:87], v2, s[48:51], s10 offen offset:128 nt
    s_waitcnt vmcnt(3)
    buffer_load_dwordx4 v[88:91], v2, s[48:51], s10 offen offset:256 nt
    s_waitcnt vmcnt(3)
    buffer_load_dwordx4 v[92:95], v2, s[48:51], s11 offen offset:0 nt
    s_waitcnt vmcnt(3)
    buffer_load_dwordx4 v[96:99], v2, s[48:51], s11 offen offset:128 nt
    s_waitcnt vmcnt(3)
    buffer_load_dwordx4 v[100:103], v2, s[48:51], s11 offen offset:256 nt
    s_waitcnt lgkmcnt(0)
    s_and_b32 s88, s92, 0x7ff
    s_xor_b32 s89, s88, 0x2a5
    s_lshr_b32 s90, s92, 11
    s_and_b32 s90, s90, 0x7ff
    s_lshr_b32 s91, s92, 22
    s_xor_b32 s91, s91, 0x4d3
    v_and_b32 v3, 7, v1
    v_lshlrev_b32 v3, 4, v3
    s_barrier
    ds_read_b128 v[120:123], v3 offset:16896
    ds_read_b128 v[124:127], v3 offset:17024
    ds_read_b128 v[128:131], v3 offset:17152
    s_waitcnt lgkmcnt(0)
    v_dot2_f32_bf16 v156, v8, v120, 0
    v_dot2_f32_bf16 v165, v12, v124, 0
    v_dot2_f32_bf16 v166, v16, v128, 0
    v_dot2_f32_bf16 v156, v9, v121, v156
    v_dot2_f32_bf16 v165, v13, v125, v165
    v_dot2_f32_bf16 v166, v17, v129, v166
    v_dot2_f32_bf16 v156, v10, v122, v156
    v_dot2_f32_bf16 v165, v14, v126, v165
    v_dot2_f32_bf16 v166, v18, v130, v166
    v_dot2_f32_bf16 v156, v11, v123, v156
    v_dot2_f32_bf16 v165, v15, v127, v165
    v_dot2_f32_bf16 v166, v19, v131, v166
    buffer_load_dwordx4 v[8:11], v2, s[52:55], s4 offen offset:0 nt
    buffer_load_dwordx4 v[12:15], v2, s[52:55], s4 offen offset:128 nt
    buffer_load_dwordx4 v[16:19], v2, s[52:55], s4 offen offset:256 nt
    v_add_f32 v156, v156, v165
    v_add_f32 v156, v156, v166
    v_dot2_f32_bf16 v157, v20, v120, 0
    v_dot2_f32_bf16 v165, v24, v124, 0
    v_dot2_f32_bf16 v166, v28, v128, 0
    v_dot2_f32_bf16 v157, v21, v121, v157
    v_dot2_f32_bf16 v165, v25, v125, v165
    v_dot2_f32_bf16 v166, v29, v129, v166
    v_dot2_f32_bf16 v157, v22, v122, v157
    v_dot2_f32_bf16 v165, v26, v126, v165
    v_dot2_f32_bf16 v166, v30, v130, v166
    v_dot2_f32_bf16 v157, v23, v123, v157
    v_dot2_f32_bf16 v165, v27, v127, v165
    v_dot2_f32_bf16 v166, v31, v131, v166
    buffer_load_dwordx4 v[20:23], v2, s[52:55], s5 offen offset:0 nt
    buffer_load_dwordx4 v[24:27], v2, s[52:55], s5 offen offset:128 nt
    buffer_load_dwordx4 v[28:31], v2, s[52:55], s5 offen offset:256 nt
    v_add_f32 v157, v157, v165
    v_add_f32 v157, v157, v166
    v_dot2_f32_bf16 v158, v32, v120, 0
    v_dot2_f32_bf16 v165, v36, v124, 0
    v_dot2_f32_bf16 v166, v40, v128, 0
    v_dot2_f32_bf16 v158, v33, v121, v158
    v_dot2_f32_bf16 v165, v37, v125, v165
    v_dot2_f32_bf16 v166, v41, v129, v166
    v_dot2_f32_bf16 v158, v34, v122, v158
    v_dot2_f32_bf16 v165, v38, v126, v165
    v_dot2_f32_bf16 v166, v42, v130, v166
    v_dot2_f32_bf16 v158, v35, v123, v158
    v_dot2_f32_bf16 v165, v39, v127, v165
    v_dot2_f32_bf16 v166, v43, v131, v166
    buffer_load_dwordx4 v[32:35], v2, s[52:55], s6 offen offset:0 nt
    buffer_load_dwordx4 v[36:39], v2, s[52:55], s6 offen offset:128 nt
    buffer_load_dwordx4 v[40:43], v2, s[52:55], s6 offen offset:256 nt
    v_add_f32 v158, v158, v165
    v_add_f32 v158, v158, v166
    v_dot2_f32_bf16 v159, v44, v120, 0
    v_dot2_f32_bf16 v165, v48, v124, 0
    v_dot2_f32_bf16 v166, v52, v128, 0
    v_dot2_f32_bf16 v159, v45, v121, v159
    v_dot2_f32_bf16 v165, v49, v125, v165
    v_dot2_f32_bf16 v166, v53, v129, v166
    v_dot2_f32_bf16 v159, v46, v122, v159
    v_dot2_f32_bf16 v165, v50, v126, v165
    v_dot2_f32_bf16 v166, v54, v130, v166
    v_dot2_f32_bf16 v159, v47, v123, v159
    v_dot2_f32_bf16 v165, v51, v127, v165
    v_dot2_f32_bf16 v166, v55, v131, v166
    buffer_load_dwordx4 v[44:47], v2, s[52:55], s7 offen offset:0 nt
    buffer_load_dwordx4 v[48:51], v2, s[52:55], s7 offen offset:128 nt
    buffer_load_dwordx4 v[52:55], v2, s[52:55], s7 offen offset:256 nt
    v_add_f32 v159, v159, v165
    v_add_f32 v159, v159, v166
    v_dot2_f32_bf16 v160, v56, v120, 0
    v_dot2_f32_bf16 v165, v60, v124, 0
    v_dot2_f32_bf16 v166, v64, v128, 0
    v_dot2_f32_bf16 v160, v57, v121, v160
    v_dot2_f32_bf16 v165, v61, v125, v165
    v_dot2_f32_bf16 v166, v65, v129, v166
    v_dot2_f32_bf16 v160, v58, v122, v160
    v_dot2_f32_bf16 v165, v62, v126, v165
    v_dot2_f32_bf16 v166, v66, v130, v166
    v_dot2_f32_bf16 v160, v59, v123, v160
    v_dot2_f32_bf16 v165, v63, v127, v165
    v_dot2_f32_bf16 v166, v67, v131, v166
    buffer_load_dwordx4 v[56:59], v2, s[52:55], s8 offen offset:0 nt
    buffer_load_dwordx4 v[60:63], v2, s[52:55], s8 offen offset:128 nt
    buffer_load_dwordx4 v[64:67], v2, s[52:55], s8 offen offset:256 nt
    v_add_f32 v160, v160, v165
    v_add_f32 v160, v160, v166
    v_dot2_f32_bf16 v161, v68, v120, 0
    v_dot2_f32_bf16 v165, v72, v124, 0
    v_dot2_f32_bf16 v166, v76, v128, 0
    v_dot2_f32_bf16 v161, v69, v121, v161
    v_dot2_f32_bf16 v165, v73, v125, v165
    v_dot2_f32_bf16 v166, v77, v129, v166
    v_dot2_f32_bf16 v161, v70, v122, v161
    v_dot2_f32_bf16 v165, v74, v126, v165
    v_dot2_f32_bf16 v166, v78, v130, v166
    v_dot2_f32_bf16 v161, v71, v123, v161
    v_dot2_f32_bf16 v165, v75, v127, v165
    v_dot2_f32_bf16 v166, v79, v131, v166
    buffer_load_dwordx4 v[68:71], v2, s[52:55], s9 offen offset:0 nt
    buffer_load_dwordx4 v[72:75], v2, s[52:55], s9 offen offset:128 nt
    buffer_load_dwordx4 v[76:79], v2, s[52:55], s9 offen offset:256 nt
    v_add_f32 v161, v161, v165
    v_add_f32 v161, v161, v166
    s_waitcnt vmcnt(21)
    v_dot2_f32_bf16 v162, v80, v120, 0
    v_dot2_f32_bf16 v165, v84, v124, 0
    v_dot2_f32_bf16 v166, v88, v128, 0
    v_dot2_f32_bf16 v162, v81, v121, v162
    v_dot2_f32_bf16 v165, v85, v125, v165
    v_dot2_f32_bf16 v166, v89, v129, v166
    v_dot2_f32_bf16 v162, v82, v122, v162
    v_dot2_f32_bf16 v165, v86, v126, v165
    v_dot2_f32_bf16 v166, v90, v130, v166
    v_dot2_f32_bf16 v162, v83, v123, v162
    v_dot2_f32_bf16 v165, v87, v127, v165
    v_dot2_f32_bf16 v166, v91, v131, v166
    buffer_load_dwordx4 v[80:83], v2, s[52:55], s10 offen offset:0 nt
    buffer_load_dwordx4 v[84:87], v2, s[52:55], s10 offen offset:128 nt
    buffer_load_dwordx4 v[88:91], v2, s[52:55], s10 offen offset:256 nt
    v_add_f32 v162, v162, v165
    v_add_f32 v162, v162, v166
    s_waitcnt vmcnt(21)
    v_dot2_f32_bf16 v163, v92, v120, 0
    v_dot2_f32_bf16 v165, v96, v124, 0
    v_dot2_f32_bf16 v166, v100, v128, 0
    v_dot2_f32_bf16 v163, v93, v121, v163
    v_dot2_f32_bf16 v165, v97, v125, v165
    v_dot2_f32_bf16 v166, v101, v129, v166
    v_dot2_f32_bf16 v163, v94, v122, v163
    v_dot2_f32_bf16 v165, v98, v126, v165
    v_dot2_f32_bf16 v166, v102, v130, v166
    v_dot2_f32_bf16 v163, v95, v123, v163
    v_dot2_f32_bf16 v165, v99, v127, v165
    v_dot2_f32_bf16 v166, v103, v131, v166
    buffer_load_dwordx4 v[92:95], v2, s[52:55], s11 offen offset:0 nt
    buffer_load_dwordx4 v[96:99], v2, s[52:55], s11 offen offset:128 nt
    buffer_load_dwordx4 v[100:103], v2, s[52:55], s11 offen offset:256 nt
    v_add_f32 v163, v163, v165
    v_add_f32 v163, v163, v166
    v_add_f32_dpp v156, v156, v156 quad_perm:[1,0,3,2] row_mask:0xf bank_mask:0xf
    v_add_f32_dpp v157, v157, v157 quad_perm:[1,0,3,2] row_mask:0xf bank_mask:0xf
    v_add_f32_dpp v158, v158, v158 quad_perm:[1,0,3,2] row_mask:0xf bank_mask:0xf
    v_add_f32_dpp v159, v159, v159 quad_perm:[1,0,3,2] row_mask:0xf bank_mask:0xf
    v_add_f32_dpp v160, v160, v160 quad_perm:[1,0,3,2] row_mask:0xf bank_mask:0xf
    v_add_f32_dpp v161, v161, v161 quad_perm:[1,0,3,2] row_mask:0xf bank_mask:0xf
    v_add_f32_dpp v162, v162, v162 quad_perm:[1,0,3,2] row_mask:0xf bank_mask:0xf
    v_add_f32_dpp v163, v163, v163 quad_perm:[1,0,3,2] row_mask:0xf bank_mask:0xf
    v_add_f32_dpp v156, v156, v156 quad_perm:[2,3,0,1] row_mask:0xf bank_mask:0xf
    v_add_f32_dpp v157, v157, v157 quad_perm:[2,3,0,1] row_mask:0xf bank_mask:0xf
    v_add_f32_dpp v158, v158, v158 quad_perm:[2,3,0,1] row_mask:0xf bank_mask:0xf
    v_add_f32_dpp v159, v159, v159 quad_perm:[2,3,0,1] row_mask:0xf bank_mask:0xf
    v_add_f32_dpp v160, v160, v160 quad_perm:[2,3,0,1] row_mask:0xf bank_mask:0xf
    v_add_f32_dpp v161, v161, v161 quad_perm:[2,3,0,1] row_mask:0xf bank_mask:0xf
    v_add_f32_dpp v162, v162, v162 quad_perm:[2,3,0,1] row_mask:0xf bank_mask:0xf
    v_add_f32_dpp v163, v163, v163 quad_perm:[2,3,0,1] row_mask:0xf bank_mask:0xf
    v_add_f32_dpp v156, v156, v156 row_half_mirror row_mask:0xf bank_mask:0xf
    v_add_f32_dpp v157, v157, v157 row_half_mirror row_mask:0xf bank_mask:0xf
    v_add_f32_dpp v158, v158, v158 row_half_mirror row_mask:0xf bank_mask:0xf
    v_add_f32_dpp v159, v159, v159 row_half_mirror row_mask:0xf bank_mask:0xf
    v_add_f32_dpp v160, v160, v160 row_half_mirror row_mask:0xf bank_mask:0xf
    v_add_f32_dpp v161, v161, v161 row_half_mirror row_mask:0xf bank_mask:0xf
    v_add_f32_dpp v162, v162, v162 row_half_mirror row_mask:0xf bank_mask:0xf
    v_add_f32_dpp v163, v163, v163 row_half_mirror row_mask:0xf bank_mask:0xf
    v_cvt_pk_bf16_f32 v156, 0, v156
    v_cvt_pk_bf16_f32 v157, 0, v157
    v_cvt_pk_bf16_f32 v158, 0, v158
    v_cvt_pk_bf16_f32 v159, 0, v159
    v_cvt_pk_bf16_f32 v160, 0, v160
    v_cvt_pk_bf16_f32 v161, 0, v161
    v_cvt_pk_bf16_f32 v162, 0, v162
    v_cvt_pk_bf16_f32 v163, 0, v163
    v_mul_f32 v156, 0x3d93cd3a, v156
    v_mul_f32 v157, 0x3d93cd3a, v157
    v_mul_f32 v158, 0x3d93cd3a, v158
    v_mul_f32 v159, 0x3d93cd3a, v159
    v_mul_f32 v160, 0x3d93cd3a, v160
    v_mul_f32 v161, 0x3d93cd3a, v161
    v_mul_f32 v162, 0x3d93cd3a, v162
    v_mul_f32 v163, 0x3d93cd3a, v163
    v_cvt_pk_bf16_f32 v156, 0, v156
    v_cvt_pk_bf16_f32 v157, 0, v157
    v_cvt_pk_bf16_f32 v158, 0, v158
    v_cvt_pk_bf16_f32 v159, 0, v159
    v_cvt_pk_bf16_f32 v160, 0, v160
    v_cvt_pk_bf16_f32 v161, 0, v161
    v_cvt_pk_bf16_f32 v162, 0, v162
    v_cvt_pk_bf16_f32 v163, 0, v163
    v_max3_f32 v4, v156, v157, v158
    v_max3_f32 v5, v159, v160, v161
    v_max3_f32 v4, v4, v162, v163
    v_max_f32 v4, v4, v5
    s_nop 1
    v_max_f32_dpp v4, v4, v4 row_ror:8 row_mask:0xf bank_mask:0xf
    v_mov_b32 v164, v4
    s_nop 1
    v_permlane16_swap_b32 v4, v164
    v_max_f32 v4, v4, v164
    v_mov_b32 v164, v4
    s_nop 1
    v_permlane32_swap_b32 v4, v164
    v_max_f32 v4, v4, v164
    v_sub_f32 v156, v156, v4
    v_sub_f32 v157, v157, v4
    v_sub_f32 v158, v158, v4
    v_sub_f32 v159, v159, v4
    v_sub_f32 v160, v160, v4
    v_sub_f32 v161, v161, v4
    v_sub_f32 v162, v162, v4
    v_sub_f32 v163, v163, v4
    v_mul_f32 v156, 0x3fb8aa3b, v156
    v_mul_f32 v157, 0x3fb8aa3b, v157
    v_mul_f32 v158, 0x3fb8aa3b, v158
    v_mul_f32 v159, 0x3fb8aa3b, v159
    v_mul_f32 v160, 0x3fb8aa3b, v160
    v_mul_f32 v161, 0x3fb8aa3b, v161
    v_mul_f32 v162, 0x3fb8aa3b, v162
    v_mul_f32 v163, 0x3fb8aa3b, v163
    v_exp_f32 v156, v156
    v_exp_f32 v157, v157
    v_exp_f32 v158, v158
    v_exp_f32 v159, v159
    v_exp_f32 v160, v160
    v_exp_f32 v161, v161
    v_exp_f32 v162, v162
    v_exp_f32 v163, v163
    v_add_f32 v5, v156, v157
    v_add_f32 v5, v5, v158
    v_add_f32 v5, v5, v159
    v_add_f32 v5, v5, v160
    v_add_f32 v5, v5, v161
    v_add_f32 v5, v5, v162
    v_add_f32 v5, v5, v163
    s_nop 1
    v_add_f32_dpp v5, v5, v5 row_ror:8 row_mask:0xf bank_mask:0xf
    v_mov_b32 v164, v5
    s_nop 1
    v_permlane16_swap_b32 v5, v164
    v_add_f32 v5, v5, v164
    v_mov_b32 v164, v5
    s_nop 1
    v_permlane32_swap_b32 v5, v164
    v_add_f32 v5, v5, v164
    s_lshl_b32 s94, s3, 3
    v_mov_b32 v3, s94
    ds_write_b64 v3, v[4:5] offset:17408
    v_and_b32 v3, 7, v1
    v_mul_u32_u24 v3, 96, v3
    v_lshrrev_b32 v4, 4, v1
    v_mad_u32_u24 v3, v4, 24, v3
    s_mul_i32 s94, s3, 768
    v_add_u32 v3, s94, v3
    v_lshrrev_b32 v6, 3, v1
    v_mul_u32_u24 v6, 5120, v6
    v_and_b32 v7, 7, v1
    v_lshl_add_u32 v6, v7, 4, v6
    s_mul_i32 s94, s3, 40960
    s_cmp_ge_u32 s2, 240
    s_cselect_b32 s94, 0x40000000, s94
    v_add_u32 v6, s94, v6
    buffer_load_dwordx4 v[104:107], v6, s[60:63], 0 offen offset:0 nt
    buffer_load_dwordx4 v[108:111], v6, s[60:63], 0 offen offset:1280 nt
    buffer_load_dwordx4 v[112:115], v6, s[60:63], 0 offen offset:2560 nt
    buffer_load_dwordx4 v[116:119], v6, s[60:63], 0 offen offset:3840 nt
    v_lshlrev_b32 v7, 1, v0
    buffer_load_ushort v120, v7, s[68:71], 0 offen offset:0
    buffer_load_ushort v121, v7, s[68:71], 0 offen offset:1024
    buffer_load_ushort v122, v7, s[68:71], 0 offen offset:2048
    buffer_load_ushort v124, v7, s[72:75], 0 offen offset:0
    buffer_load_ushort v125, v7, s[72:75], 0 offen offset:1024
    buffer_load_ushort v126, v7, s[72:75], 0 offen offset:2048
    buffer_load_ushort v128, v7, s[76:79], 0 offen offset:0
    buffer_load_ushort v129, v7, s[76:79], 0 offen offset:1024
    buffer_load_ushort v130, v7, s[76:79], 0 offen offset:2048
    v_cvt_pk_bf16_f32 v164, v156, 0
    v_cvt_pk_bf16_f32 v165, 0, v156
    s_waitcnt vmcnt(34)
    v_dot2_f32_bf16 v132, v8, v164, 0
    v_dot2_f32_bf16 v133, v8, v165, 0
    v_dot2_f32_bf16 v134, v9, v164, 0
    v_dot2_f32_bf16 v135, v9, v165, 0
    v_dot2_f32_bf16 v136, v10, v164, 0
    v_dot2_f32_bf16 v137, v10, v165, 0
    v_dot2_f32_bf16 v138, v11, v164, 0
    v_dot2_f32_bf16 v139, v11, v165, 0
    v_dot2_f32_bf16 v140, v12, v164, 0
    v_dot2_f32_bf16 v141, v12, v165, 0
    v_dot2_f32_bf16 v142, v13, v164, 0
    v_dot2_f32_bf16 v143, v13, v165, 0
    v_dot2_f32_bf16 v144, v14, v164, 0
    v_dot2_f32_bf16 v145, v14, v165, 0
    v_dot2_f32_bf16 v146, v15, v164, 0
    v_dot2_f32_bf16 v147, v15, v165, 0
    v_dot2_f32_bf16 v148, v16, v164, 0
    v_dot2_f32_bf16 v149, v16, v165, 0
    v_dot2_f32_bf16 v150, v17, v164, 0
    v_dot2_f32_bf16 v151, v17, v165, 0
    v_dot2_f32_bf16 v152, v18, v164, 0
    v_dot2_f32_bf16 v153, v18, v165, 0
    v_dot2_f32_bf16 v154, v19, v164, 0
    v_dot2_f32_bf16 v155, v19, v165, 0
    v_cvt_pk_bf16_f32 v164, v157, 0
    v_cvt_pk_bf16_f32 v165, 0, v157
    s_waitcnt vmcnt(31)
    v_dot2_f32_bf16 v132, v20, v164, v132
    v_dot2_f32_bf16 v133, v20, v165, v133
    v_dot2_f32_bf16 v134, v21, v164, v134
    v_dot2_f32_bf16 v135, v21, v165, v135
    v_dot2_f32_bf16 v136, v22, v164, v136
    v_dot2_f32_bf16 v137, v22, v165, v137
    v_dot2_f32_bf16 v138, v23, v164, v138
    v_dot2_f32_bf16 v139, v23, v165, v139
    v_dot2_f32_bf16 v140, v24, v164, v140
    v_dot2_f32_bf16 v141, v24, v165, v141
    v_dot2_f32_bf16 v142, v25, v164, v142
    v_dot2_f32_bf16 v143, v25, v165, v143
    v_dot2_f32_bf16 v144, v26, v164, v144
    v_dot2_f32_bf16 v145, v26, v165, v145
    v_dot2_f32_bf16 v146, v27, v164, v146
    v_dot2_f32_bf16 v147, v27, v165, v147
    v_dot2_f32_bf16 v148, v28, v164, v148
    v_dot2_f32_bf16 v149, v28, v165, v149
    v_dot2_f32_bf16 v150, v29, v164, v150
    v_dot2_f32_bf16 v151, v29, v165, v151
    v_dot2_f32_bf16 v152, v30, v164, v152
    v_dot2_f32_bf16 v153, v30, v165, v153
    v_dot2_f32_bf16 v154, v31, v164, v154
    v_dot2_f32_bf16 v155, v31, v165, v155
    v_cvt_pk_bf16_f32 v164, v158, 0
    v_cvt_pk_bf16_f32 v165, 0, v158
    s_waitcnt vmcnt(28)
    v_dot2_f32_bf16 v132, v32, v164, v132
    v_dot2_f32_bf16 v133, v32, v165, v133
    v_dot2_f32_bf16 v134, v33, v164, v134
    v_dot2_f32_bf16 v135, v33, v165, v135
    v_dot2_f32_bf16 v136, v34, v164, v136
    v_dot2_f32_bf16 v137, v34, v165, v137
    v_dot2_f32_bf16 v138, v35, v164, v138
    v_dot2_f32_bf16 v139, v35, v165, v139
    v_dot2_f32_bf16 v140, v36, v164, v140
    v_dot2_f32_bf16 v141, v36, v165, v141
    v_dot2_f32_bf16 v142, v37, v164, v142
    v_dot2_f32_bf16 v143, v37, v165, v143
    v_dot2_f32_bf16 v144, v38, v164, v144
    v_dot2_f32_bf16 v145, v38, v165, v145
    v_dot2_f32_bf16 v146, v39, v164, v146
    v_dot2_f32_bf16 v147, v39, v165, v147
    v_dot2_f32_bf16 v148, v40, v164, v148
    v_dot2_f32_bf16 v149, v40, v165, v149
    v_dot2_f32_bf16 v150, v41, v164, v150
    v_dot2_f32_bf16 v151, v41, v165, v151
    v_dot2_f32_bf16 v152, v42, v164, v152
    v_dot2_f32_bf16 v153, v42, v165, v153
    v_dot2_f32_bf16 v154, v43, v164, v154
    v_dot2_f32_bf16 v155, v43, v165, v155
    v_cvt_pk_bf16_f32 v164, v159, 0
    v_cvt_pk_bf16_f32 v165, 0, v159
    s_waitcnt vmcnt(25)
    v_dot2_f32_bf16 v132, v44, v164, v132
    v_dot2_f32_bf16 v133, v44, v165, v133
    v_dot2_f32_bf16 v134, v45, v164, v134
    v_dot2_f32_bf16 v135, v45, v165, v135
    v_dot2_f32_bf16 v136, v46, v164, v136
    v_dot2_f32_bf16 v137, v46, v165, v137
    v_dot2_f32_bf16 v138, v47, v164, v138
    v_dot2_f32_bf16 v139, v47, v165, v139
    v_dot2_f32_bf16 v140, v48, v164, v140
    v_dot2_f32_bf16 v141, v48, v165, v141
    v_dot2_f32_bf16 v142, v49, v164, v142
    v_dot2_f32_bf16 v143, v49, v165, v143
    v_dot2_f32_bf16 v144, v50, v164, v144
    v_dot2_f32_bf16 v145, v50, v165, v145
    v_dot2_f32_bf16 v146, v51, v164, v146
    v_dot2_f32_bf16 v147, v51, v165, v147
    v_dot2_f32_bf16 v148, v52, v164, v148
    v_dot2_f32_bf16 v149, v52, v165, v149
    v_dot2_f32_bf16 v150, v53, v164, v150
    v_dot2_f32_bf16 v151, v53, v165, v151
    v_dot2_f32_bf16 v152, v54, v164, v152
    v_dot2_f32_bf16 v153, v54, v165, v153
    v_dot2_f32_bf16 v154, v55, v164, v154
    v_dot2_f32_bf16 v155, v55, v165, v155
    v_cvt_pk_bf16_f32 v164, v160, 0
    v_cvt_pk_bf16_f32 v165, 0, v160
    s_waitcnt vmcnt(22)
    v_dot2_f32_bf16 v132, v56, v164, v132
    v_dot2_f32_bf16 v133, v56, v165, v133
    v_dot2_f32_bf16 v134, v57, v164, v134
    v_dot2_f32_bf16 v135, v57, v165, v135
    v_dot2_f32_bf16 v136, v58, v164, v136
    v_dot2_f32_bf16 v137, v58, v165, v137
    v_dot2_f32_bf16 v138, v59, v164, v138
    v_dot2_f32_bf16 v139, v59, v165, v139
    v_dot2_f32_bf16 v140, v60, v164, v140
    v_dot2_f32_bf16 v141, v60, v165, v141
    v_dot2_f32_bf16 v142, v61, v164, v142
    v_dot2_f32_bf16 v143, v61, v165, v143
    v_dot2_f32_bf16 v144, v62, v164, v144
    v_dot2_f32_bf16 v145, v62, v165, v145
    v_dot2_f32_bf16 v146, v63, v164, v146
    v_dot2_f32_bf16 v147, v63, v165, v147
    v_dot2_f32_bf16 v148, v64, v164, v148
    v_dot2_f32_bf16 v149, v64, v165, v149
    v_dot2_f32_bf16 v150, v65, v164, v150
    v_dot2_f32_bf16 v151, v65, v165, v151
    v_dot2_f32_bf16 v152, v66, v164, v152
    v_dot2_f32_bf16 v153, v66, v165, v153
    v_dot2_f32_bf16 v154, v67, v164, v154
    v_dot2_f32_bf16 v155, v67, v165, v155
    v_cvt_pk_bf16_f32 v164, v161, 0
    v_cvt_pk_bf16_f32 v165, 0, v161
    s_waitcnt vmcnt(19)
    v_dot2_f32_bf16 v132, v68, v164, v132
    v_dot2_f32_bf16 v133, v68, v165, v133
    v_dot2_f32_bf16 v134, v69, v164, v134
    v_dot2_f32_bf16 v135, v69, v165, v135
    v_dot2_f32_bf16 v136, v70, v164, v136
    v_dot2_f32_bf16 v137, v70, v165, v137
    v_dot2_f32_bf16 v138, v71, v164, v138
    v_dot2_f32_bf16 v139, v71, v165, v139
    v_dot2_f32_bf16 v140, v72, v164, v140
    v_dot2_f32_bf16 v141, v72, v165, v141
    v_dot2_f32_bf16 v142, v73, v164, v142
    v_dot2_f32_bf16 v143, v73, v165, v143
    v_dot2_f32_bf16 v144, v74, v164, v144
    v_dot2_f32_bf16 v145, v74, v165, v145
    v_dot2_f32_bf16 v146, v75, v164, v146
    v_dot2_f32_bf16 v147, v75, v165, v147
    v_dot2_f32_bf16 v148, v76, v164, v148
    v_dot2_f32_bf16 v149, v76, v165, v149
    v_dot2_f32_bf16 v150, v77, v164, v150
    v_dot2_f32_bf16 v151, v77, v165, v151
    v_dot2_f32_bf16 v152, v78, v164, v152
    v_dot2_f32_bf16 v153, v78, v165, v153
    v_dot2_f32_bf16 v154, v79, v164, v154
    v_dot2_f32_bf16 v155, v79, v165, v155
    v_cvt_pk_bf16_f32 v164, v162, 0
    v_cvt_pk_bf16_f32 v165, 0, v162
    s_waitcnt vmcnt(16)
    v_dot2_f32_bf16 v132, v80, v164, v132
    v_dot2_f32_bf16 v133, v80, v165, v133
    v_dot2_f32_bf16 v134, v81, v164, v134
    v_dot2_f32_bf16 v135, v81, v165, v135
    v_dot2_f32_bf16 v136, v82, v164, v136
    v_dot2_f32_bf16 v137, v82, v165, v137
    v_dot2_f32_bf16 v138, v83, v164, v138
    v_dot2_f32_bf16 v139, v83, v165, v139
    v_dot2_f32_bf16 v140, v84, v164, v140
    v_dot2_f32_bf16 v141, v84, v165, v141
    v_dot2_f32_bf16 v142, v85, v164, v142
    v_dot2_f32_bf16 v143, v85, v165, v143
    v_dot2_f32_bf16 v144, v86, v164, v144
    v_dot2_f32_bf16 v145, v86, v165, v145
    v_dot2_f32_bf16 v146, v87, v164, v146
    v_dot2_f32_bf16 v147, v87, v165, v147
    v_dot2_f32_bf16 v148, v88, v164, v148
    v_dot2_f32_bf16 v149, v88, v165, v149
    v_dot2_f32_bf16 v150, v89, v164, v150
    v_dot2_f32_bf16 v151, v89, v165, v151
    v_dot2_f32_bf16 v152, v90, v164, v152
    v_dot2_f32_bf16 v153, v90, v165, v153
    v_dot2_f32_bf16 v154, v91, v164, v154
    v_dot2_f32_bf16 v155, v91, v165, v155
    v_cvt_pk_bf16_f32 v164, v163, 0
    v_cvt_pk_bf16_f32 v165, 0, v163
    s_waitcnt vmcnt(13)
    v_dot2_f32_bf16 v132, v92, v164, v132
    v_dot2_f32_bf16 v133, v92, v165, v133
    v_dot2_f32_bf16 v134, v93, v164, v134
    v_dot2_f32_bf16 v135, v93, v165, v135
    v_dot2_f32_bf16 v136, v94, v164, v136
    v_dot2_f32_bf16 v137, v94, v165, v137
    v_dot2_f32_bf16 v138, v95, v164, v138
    v_dot2_f32_bf16 v139, v95, v165, v139
    v_dot2_f32_bf16 v140, v96, v164, v140
    v_dot2_f32_bf16 v141, v96, v165, v141
    v_dot2_f32_bf16 v142, v97, v164, v142
    v_dot2_f32_bf16 v143, v97, v165, v143
    v_dot2_f32_bf16 v144, v98, v164, v144
    v_dot2_f32_bf16 v145, v98, v165, v145
    v_dot2_f32_bf16 v146, v99, v164, v146
    v_dot2_f32_bf16 v147, v99, v165, v147
    v_dot2_f32_bf16 v148, v100, v164, v148
    v_dot2_f32_bf16 v149, v100, v165, v149
    v_dot2_f32_bf16 v150, v101, v164, v150
    v_dot2_f32_bf16 v151, v101, v165, v151
    v_dot2_f32_bf16 v152, v102, v164, v152
    v_dot2_f32_bf16 v153, v102, v165, v153
    v_dot2_f32_bf16 v154, v103, v164, v154
    v_dot2_f32_bf16 v155, v103, v165, v155
    v_permlane32_swap_b32 v132, v144
    v_permlane32_swap_b32 v133, v145
    v_permlane32_swap_b32 v134, v146
    v_permlane32_swap_b32 v135, v147
    v_permlane32_swap_b32 v136, v148
    v_permlane32_swap_b32 v137, v149
    v_permlane32_swap_b32 v138, v150
    v_permlane32_swap_b32 v139, v151
    v_permlane32_swap_b32 v140, v152
    v_permlane32_swap_b32 v141, v153
    v_permlane32_swap_b32 v142, v154
    v_permlane32_swap_b32 v143, v155
    v_add_f32 v132, v132, v144
    v_add_f32 v133, v133, v145
    v_add_f32 v134, v134, v146
    v_add_f32 v135, v135, v147
    v_add_f32 v136, v136, v148
    v_add_f32 v137, v137, v149
    v_add_f32 v138, v138, v150
    v_add_f32 v139, v139, v151
    v_add_f32 v140, v140, v152
    v_add_f32 v141, v141, v153
    v_add_f32 v142, v142, v154
    v_add_f32 v143, v143, v155
    v_permlane16_swap_b32 v132, v138
    v_permlane16_swap_b32 v133, v139
    v_permlane16_swap_b32 v134, v140
    v_permlane16_swap_b32 v135, v141
    v_permlane16_swap_b32 v136, v142
    v_permlane16_swap_b32 v137, v143
    v_add_f32 v132, v132, v138
    v_add_f32 v133, v133, v139
    v_add_f32 v134, v134, v140
    v_add_f32 v135, v135, v141
    v_add_f32 v136, v136, v142
    v_add_f32 v137, v137, v143
    v_add_f32_dpp v132, v132, v132 row_ror:8 row_mask:0xf bank_mask:0xf
    v_add_f32_dpp v133, v133, v133 row_ror:8 row_mask:0xf bank_mask:0xf
    v_add_f32_dpp v134, v134, v134 row_ror:8 row_mask:0xf bank_mask:0xf
    v_add_f32_dpp v135, v135, v135 row_ror:8 row_mask:0xf bank_mask:0xf
    v_add_f32_dpp v136, v136, v136 row_ror:8 row_mask:0xf bank_mask:0xf
    v_add_f32_dpp v137, v137, v137 row_ror:8 row_mask:0xf bank_mask:0xf
    ds_write_b64 v3, v[132:133] offset:17920
    ds_write_b64 v3, v[134:135] offset:17928
    ds_write_b64 v3, v[136:137] offset:17936
    s_waitcnt lgkmcnt(0)
    s_barrier
    s_cmp_ge_u32 s2, 240
    s_cbranch_scc1 L_stream_end
    s_lshl_b32 s94, s14, 3
    s_add_u32 s94, s94, s3
    s_mul_i32 s95, s94, 171
    s_lshr_b32 s95, s95, 10
    s_mul_i32 s96, s95, 6
    s_sub_u32 s94, s94, s96
    s_lshl_b32 s94, s94, 7
    s_lshl_b32 s95, s95, 13
    s_add_u32 s95, s95, 327680
    s_add_u32 s94, s94, s95
    v_and_b32 v3, 7, v1
    v_lshlrev_b32 v3, 10, v3
    v_lshrrev_b32 v4, 3, v1
    v_lshl_add_u32 v4, v4, 4, v3
    s_mov_b32 s93, 20000
h1ml_poll:
    buffer_load_dwordx4 v[12:15], v3, s[64:67], s95 offen offset:768 sc1
    s_waitcnt vmcnt(0)
    v_xor_b32 v16, s88, v12
    v_xor_b32 v17, s89, v13
    v_xor_b32 v18, s90, v14
    v_xor_b32 v19, s91, v15
    v_or3_b32 v16, v16, v17, v18
    v_or_b32 v16, v16, v19
    v_and_b32 v16, 0x7ff, v16
    v_cmp_ne_u32 vcc, 0, v16
    s_cbranch_vccz h1ml_ok
    s_mov_b64 exec, vcc
    s_sleep 1
    s_sub_u32 s93, s93, 1
    s_cmp_lg_u32 s93, 0
    s_cbranch_scc1 h1ml_poll
h1ml_ok:
    s_mov_b64 exec, -1
    v_and_b32 v12, 0xffff0000, v12
    v_mov_b32 v5, v12
    s_nop 1
    v_max_f32_dpp v5, v5, v5 quad_perm:[1,0,3,2] row_mask:0xf bank_mask:0xf
    s_nop 1
    v_max_f32_dpp v5, v5, v5 quad_perm:[2,3,0,1] row_mask:0xf bank_mask:0xf
    s_nop 1
    v_max_f32_dpp v5, v5, v5 row_half_mirror row_mask:0xf bank_mask:0xf
    v_sub_f32 v5, v12, v5
    v_mul_f32 v5, 0x3fb8aa3b, v5
    v_exp_f32 v5, v5
    s_nop 0
    v_mul_f32 v6, v5, v13
    s_nop 1
    v_add_f32_dpp v6, v6, v6 quad_perm:[1,0,3,2] row_mask:0xf bank_mask:0xf
    s_nop 1
    v_add_f32_dpp v6, v6, v6 quad_perm:[2,3,0,1] row_mask:0xf bank_mask:0xf
    s_nop 1
    v_add_f32_dpp v6, v6, v6 row_half_mirror row_mask:0xf bank_mask:0xf
    v_rcp_f32 v6, v6
    s_nop 0
    v_mul_f32 v5, v5, v6
    s_mov_b32 s95, 0x05040100
    s_mov_b32 s96, 0x07060302
    v_perm_b32 v24, v108, v104, s95
    v_perm_b32 v25, v108, v104, s96
    v_perm_b32 v26, v109, v105, s95
    v_perm_b32 v27, v109, v105, s96
    v_perm_b32 v28, v110, v106, s95
    v_perm_b32 v29, v110, v106, s96
    v_perm_b32 v30, v111, v107, s95
    v_perm_b32 v31, v111, v107, s96
    v_perm_b32 v32, v116, v112, s95
    v_perm_b32 v33, v116, v112, s96
    v_perm_b32 v34, v117, v113, s95
    v_perm_b32 v35, v117, v113, s96
    v_perm_b32 v36, v118, v114, s95
    v_perm_b32 v37, v118, v114, s96
    v_perm_b32 v38, v119, v115, s95
    v_perm_b32 v39, v119, v115, s96
    v_and_b32 v3, 7, v1
    v_lshlrev_b32 v3, 5, v3
    v_lshrrev_b32 v6, 4, v1
    v_lshl_add_u32 v3, v6, 3, v3
    s_lshl_b32 s95, s3, 8
    v_add_u32 v3, s95, v3
    s_mov_b32 s93, 20000
h1o_poll:
    buffer_load_dwordx4 v[8:11], v4, s[64:67], s94 offen sc1
    s_waitcnt vmcnt(0)
    v_xor_b32 v16, s88, v8
    v_xor_b32 v17, s89, v9
    v_xor_b32 v18, s90, v10
    v_xor_b32 v19, s91, v11
    v_or3_b32 v16, v16, v17, v18
    v_or_b32 v16, v16, v19
    v_and_b32 v16, 0x7ff, v16
    v_cmp_ne_u32 vcc, 0, v16
    s_cbranch_vccz h1o_ok
    s_mov_b64 exec, vcc
    s_sleep 1
    s_sub_u32 s93, s93, 1
    s_cmp_lg_u32 s93, 0
    s_cbranch_scc1 h1o_poll
h1o_ok:
    s_mov_b64 exec, -1
    v_mul_f32 v156, v5, v8
    v_mul_f32 v157, v5, v9
    v_mul_f32 v158, v5, v10
    v_mul_f32 v159, v5, v11
    v_add_f32_dpp v156, v156, v156 quad_perm:[1,0,3,2] row_mask:0xf bank_mask:0xf
    v_add_f32_dpp v157, v157, v157 quad_perm:[1,0,3,2] row_mask:0xf bank_mask:0xf
    v_add_f32_dpp v158, v158, v158 quad_perm:[1,0,3,2] row_mask:0xf bank_mask:0xf
    v_add_f32_dpp v159, v159, v159 quad_perm:[1,0,3,2] row_mask:0xf bank_mask:0xf
    v_add_f32_dpp v156, v156, v156 quad_perm:[2,3,0,1] row_mask:0xf bank_mask:0xf
    v_add_f32_dpp v157, v157, v157 quad_perm:[2,3,0,1] row_mask:0xf bank_mask:0xf
    v_add_f32_dpp v158, v158, v158 quad_perm:[2,3,0,1] row_mask:0xf bank_mask:0xf
    v_add_f32_dpp v159, v159, v159 quad_perm:[2,3,0,1] row_mask:0xf bank_mask:0xf
    v_add_f32_dpp v156, v156, v156 row_half_mirror row_mask:0xf bank_mask:0xf
    v_add_f32_dpp v157, v157, v157 row_half_mirror row_mask:0xf bank_mask:0xf
    v_add_f32_dpp v158, v158, v158 row_half_mirror row_mask:0xf bank_mask:0xf
    v_add_f32_dpp v159, v159, v159 row_half_mirror row_mask:0xf bank_mask:0xf
    v_cvt_pk_bf16_f32 v156, v156, v157
    v_cvt_pk_bf16_f32 v157, v158, v159
    v_dot2_f32_bf16 v132, v24, v156, 0
    v_dot2_f32_bf16 v133, v25, v156, 0
    v_dot2_f32_bf16 v134, v26, v156, 0
    v_dot2_f32_bf16 v135, v27, v156, 0
    v_dot2_f32_bf16 v136, v28, v156, 0
    v_dot2_f32_bf16 v137, v29, v156, 0
    v_dot2_f32_bf16 v138, v30, v156, 0
    v_dot2_f32_bf16 v139, v31, v156, 0
    v_dot2_f32_bf16 v132, v32, v157, v132
    v_dot2_f32_bf16 v133, v33, v157, v133
    v_dot2_f32_bf16 v134, v34, v157, v134
    v_dot2_f32_bf16 v135, v35, v157, v135
    v_dot2_f32_bf16 v136, v36, v157, v136
    v_dot2_f32_bf16 v137, v37, v157, v137
    v_dot2_f32_bf16 v138, v38, v157, v138
    v_dot2_f32_bf16 v139, v39, v157, v139
    v_permlane32_swap_b32 v132, v136
    v_permlane32_swap_b32 v133, v137
    v_permlane32_swap_b32 v134, v138
    v_permlane32_swap_b32 v135, v139
    v_add_f32 v132, v132, v136
    v_add_f32 v133, v133, v137
    v_add_f32 v134, v134, v138
    v_add_f32 v135, v135, v139
    s_nop 0
    v_permlane16_swap_b32 v132, v134
    v_permlane16_swap_b32 v133, v135
    v_add_f32 v132, v132, v134
    v_add_f32 v133, v133, v135
    s_nop 0
    v_add_f32_dpp v132, v132, v132 row_ror:8 row_mask:0xf bank_mask:0xf
    v_add_f32_dpp v133, v133, v133 row_ror:8 row_mask:0xf bank_mask:0xf
    ds_write_b64 v3, v[132:133] offset:24064
    s_waitcnt lgkmcnt(0)
    s_barrier
    s_cmp_ge_u32 s2, 214
    s_cbranch_scc1 L_stream_end
    s_mul_i32 s94, s2, 12
    s_and_b32 s94, s94, 15
    s_add_u32 s94, s94, 26112
    v_mov_b32 v3, s94
    s_waitcnt vmcnt(0)
    v_lshlrev_b32 v120, 16, v120
    v_lshlrev_b32 v121, 16, v121
    v_lshlrev_b32 v122, 16, v122
    v_lshlrev_b32 v124, 16, v124
    v_lshlrev_b32 v125, 16, v125
    v_lshlrev_b32 v126, 16, v126
    v_lshlrev_b32 v128, 16, v128
    v_lshlrev_b32 v129, 16, v129
    v_lshlrev_b32 v130, 16, v130
    v_mov_b32 v6, 0xc0135761
    v_mov_b32 v7, 0xbdd2d3e8
    s_lshl_b32 s94, s3, 2
    v_lshrrev_b32 v4, 4, v1
    v_lshl_add_u32 v4, v4, 5, s94
    v_mov_b32 v135, 0
    v_mov_b32 v64, 0xc2100000
    v_mov_b32 v65, 0x2d800000
    s_barrier
    ds_read2_b32 v[156:157], v3 offset0:0 offset1:1
    ds_read_b32 v158, v3 offset:8
    s_waitcnt lgkmcnt(1)
    v_pk_fma_f32 v[40:41], v[156:157], v[120:121], v[124:125] op_sel:[0,0,0] op_sel_hi:[1,0,0]
    v_pk_fma_f32 v[42:43], v[156:157], v[120:121], v[124:125] op_sel:[0,1,1] op_sel_hi:[1,1,1]
    v_pk_fma_f32 v[44:45], v[156:157], v[122:123], v[126:127] op_sel:[0,0,0] op_sel_hi:[1,0,0]
    s_waitcnt lgkmcnt(0)
    v_pk_fma_f32 v[46:47], v[158:159], v[120:121], v[124:125] op_sel:[0,0,0] op_sel_hi:[0,1,1]
    v_fma_f32 v48, v158, v122, v126
    v_pk_mul_f32 v[52:53], v[40:41], v[40:41]
    v_pk_mul_f32 v[54:55], v[42:43], v[42:43]
    v_pk_mul_f32 v[56:57], v[44:45], v[44:45]
    v_pk_mul_f32 v[58:59], v[46:47], v[46:47]
    v_mul_f32 v60, v48, v48
    v_pk_fma_f32 v[52:53], v[52:53], v[6:7], v[6:7] op_sel:[0,1,0] op_sel_hi:[1,1,0]
    v_pk_fma_f32 v[54:55], v[54:55], v[6:7], v[6:7] op_sel:[0,1,0] op_sel_hi:[1,1,0]
    v_pk_fma_f32 v[56:57], v[56:57], v[6:7], v[6:7] op_sel:[0,1,0] op_sel_hi:[1,1,0]
    v_pk_fma_f32 v[58:59], v[58:59], v[6:7], v[6:7] op_sel:[0,1,0] op_sel_hi:[1,1,0]
    v_fma_f32 v60, v60, v7, v6
    v_pk_fma_f32 v[52:53], v[52:53], v[40:41], v[64:65] op_sel:[0,0,0] op_sel_hi:[1,1,0]
    v_pk_fma_f32 v[54:55], v[54:55], v[42:43], v[64:65] op_sel:[0,0,0] op_sel_hi:[1,1,0]
    v_pk_fma_f32 v[56:57], v[56:57], v[44:45], v[64:65] op_sel:[0,0,0] op_sel_hi:[1,1,0]
    v_pk_fma_f32 v[58:59], v[58:59], v[46:47], v[64:65] op_sel:[0,0,0] op_sel_hi:[1,1,0]
    v_fma_f32 v60, v60, v48, v64
    v_exp_f32_e64 v52, v52 clamp
    v_exp_f32_e64 v53, v53 clamp
    v_exp_f32_e64 v54, v54 clamp
    v_exp_f32_e64 v55, v55 clamp
    v_exp_f32_e64 v56, v56 clamp
    v_exp_f32_e64 v57, v57 clamp
    v_exp_f32_e64 v58, v58 clamp
    v_exp_f32_e64 v59, v59 clamp
    v_exp_f32_e64 v60, v60 clamp
    v_pk_mul_f32 v[40:41], v[40:41], v[128:129] op_sel:[0,0] op_sel_hi:[1,0]
    v_pk_mul_f32 v[42:43], v[42:43], v[128:129] op_sel:[0,1] op_sel_hi:[1,1]
    v_pk_mul_f32 v[44:45], v[44:45], v[130:131] op_sel:[0,0] op_sel_hi:[1,0]
    v_pk_mul_f32 v[46:47], v[46:47], v[128:129]
    v_mul_f32 v48, v48, v130
    v_pk_add_f32 v[52:53], v[52:53], v[64:65] op_sel:[0,1] op_sel_hi:[1,1]
    v_pk_add_f32 v[54:55], v[54:55], v[64:65] op_sel:[0,1] op_sel_hi:[1,1]
    v_pk_add_f32 v[56:57], v[56:57], v[64:65] op_sel:[0,1] op_sel_hi:[1,1]
    v_pk_add_f32 v[58:59], v[58:59], v[64:65] op_sel:[0,1] op_sel_hi:[1,1]
    v_add_f32 v60, v65, v60
    v_pk_mul_f32 v[68:69], v[52:53], v[54:55]
    v_mul_f32 v70, v58, v59
    v_pk_mul_f32 v[72:73], v[68:69], v[56:57]
    v_mul_f32 v74, v70, v60
    v_rcp_f32 v72, v72
    v_rcp_f32 v73, v73
    v_rcp_f32 v74, v74
    v_pk_mul_f32 v[132:133], v[40:41], v[54:55]
    v_mul_f32 v134, v46, v59
    v_pk_fma_f32 v[132:133], v[42:43], v[52:53], v[132:133]
    v_fmac_f32 v134, v47, v58
    v_pk_mul_f32 v[132:133], v[132:133], v[56:57]
    v_mul_f32 v134, v134, v60
    v_pk_fma_f32 v[132:133], v[44:45], v[68:69], v[132:133]
    v_fmac_f32 v134, v48, v70
    v_pk_mul_f32 v[132:133], v[132:133], v[72:73]
    v_mul_f32 v134, v134, v74
    s_nop 1
    v_permlane32_swap_b32 v132, v134
    v_permlane32_swap_b32 v133, v135
    v_add_f32 v132, v132, v134
    v_add_f32 v133, v133, v135
    s_nop 1
    v_permlane16_swap_b32 v132, v133
    v_add_f32 v132, v132, v133
    s_nop 1
    v_add_f32_dpp v132, v132, v132 quad_perm:[1,0,3,2] row_mask:0xf bank_mask:0xf
    s_nop 1
    v_add_f32_dpp v132, v132, v132 quad_perm:[2,3,0,1] row_mask:0xf bank_mask:0xf
    s_nop 1
    v_add_f32_dpp v132, v132, v132 row_half_mirror row_mask:0xf bank_mask:0xf
    s_nop 1
    v_add_f32_dpp v132, v132, v132 row_ror:8 row_mask:0xf bank_mask:0xf
    v_mul_f32 v132, v132, v65
    ds_write_b32 v4, v132 offset:31744
    s_waitcnt lgkmcnt(0)
    s_barrier
L_stream_end:
    s_waitcnt vmcnt(0)
    s_endpgm
L_comm:
    s_setprio 3
    s_barrier
    v_mov_b32 v2, 0xfffff800
    v_and_b32 v3, 15, v1
    v_lshlrev_b32 v3, 2, v3
    v_mov_b32 v4, 0
    ds_write_b32 v3, v4 offset:17408
    s_sub_u32 s94, s2, 236
    s_lshl_b32 s94, s94, 6
    s_cmp_ge_u32 s2, 236
    s_cselect_b32 s94, s94, 0
    v_and_b32 v3, 7, v1
    v_lshlrev_b32 v3, 3, v3
    buffer_load_dwordx2 v[160:161], v3, s[44:47], s94 offen
    buffer_load_ushort v162, v4, s[84:87], 0 offen
    s_waitcnt lgkmcnt(0)
    s_and_b32 s88, s92, 0x7ff
    s_xor_b32 s89, s88, 0x2a5
    s_lshr_b32 s90, s92, 11
    s_and_b32 s90, s90, 0x7ff
    s_lshr_b32 s91, s92, 22
    s_xor_b32 s91, s91, 0x4d3
    v_lshlrev_b32 v3, 4, v1
    s_mov_b32 exec_hi, 0xffff
    s_lshl_b32 s94, s12, 3
    s_mul_i32 s95, s94, 768
    s_add_u32 s95, s95, 4096
    s_add_u32 s94, s94, s13
    s_lshl_b32 s97, s94, 10
    s_add_u32 s97, s97, 327680
    s_mul_i32 s94, s94, 768
    s_add_u32 s94, s94, 4096
    s_barrier
    ds_read_b128 v[8:11], v3 offset:0
    ds_read_b128 v[12:15], v3 offset:768
    ds_read_b128 v[16:19], v3 offset:1536
    ds_read_b128 v[20:23], v3 offset:2304
    ds_read_b128 v[24:27], v3 offset:3072
    ds_read_b128 v[28:31], v3 offset:3840
    ds_read_b128 v[32:35], v3 offset:4608
    ds_read_b128 v[36:39], v3 offset:5376
    ds_read_b128 v[40:43], v3 offset:6144
    ds_read_b128 v[44:47], v3 offset:6912
    ds_read_b128 v[48:51], v3 offset:7680
    ds_read_b128 v[52:55], v3 offset:8448
    ds_read_b128 v[56:59], v3 offset:9216
    ds_read_b128 v[60:63], v3 offset:9984
    ds_read_b128 v[64:67], v3 offset:10752
    ds_read_b128 v[68:71], v3 offset:11520
    ds_read_b128 v[72:75], v3 offset:12288
    ds_read_b128 v[76:79], v3 offset:13056
    ds_read_b128 v[80:83], v3 offset:13824
    ds_read_b128 v[84:87], v3 offset:14592
    s_waitcnt lgkmcnt(0)
    v_pk_add_f32 v[8:9], v[8:9], v[84:85]
    v_pk_add_f32 v[10:11], v[10:11], v[86:87]
    v_pk_add_f32 v[12:13], v[12:13], v[80:81]
    v_pk_add_f32 v[14:15], v[14:15], v[82:83]
    v_pk_add_f32 v[16:17], v[16:17], v[76:77]
    v_pk_add_f32 v[18:19], v[18:19], v[78:79]
    v_pk_add_f32 v[20:21], v[20:21], v[72:73]
    v_pk_add_f32 v[22:23], v[22:23], v[74:75]
    v_pk_add_f32 v[24:25], v[24:25], v[68:69]
    v_pk_add_f32 v[26:27], v[26:27], v[70:71]
    v_pk_add_f32 v[28:29], v[28:29], v[64:65]
    v_pk_add_f32 v[30:31], v[30:31], v[66:67]
    v_pk_add_f32 v[32:33], v[32:33], v[60:61]
    v_pk_add_f32 v[34:35], v[34:35], v[62:63]
    v_pk_add_f32 v[36:37], v[36:37], v[56:57]
    v_pk_add_f32 v[38:39], v[38:39], v[58:59]
    v_pk_add_f32 v[40:41], v[40:41], v[52:53]
    v_pk_add_f32 v[42:43], v[42:43], v[54:55]
    v_pk_add_f32 v[44:45], v[44:45], v[48:49]
    v_pk_add_f32 v[46:47], v[46:47], v[50:51]
    v_pk_add_f32 v[8:9], v[8:9], v[44:45]
    v_pk_add_f32 v[10:11], v[10:11], v[46:47]
    v_pk_add_f32 v[12:13], v[12:13], v[40:41]
    v_pk_add_f32 v[14:15], v[14:15], v[42:43]
    v_pk_add_f32 v[16:17], v[16:17], v[36:37]
    v_pk_add_f32 v[18:19], v[18:19], v[38:39]
    v_pk_add_f32 v[20:21], v[20:21], v[32:33]
    v_pk_add_f32 v[22:23], v[22:23], v[34:35]
    v_pk_add_f32 v[24:25], v[24:25], v[28:29]
    v_pk_add_f32 v[26:27], v[26:27], v[30:31]
    v_pk_add_f32 v[8:9], v[8:9], v[24:25]
    v_pk_add_f32 v[10:11], v[10:11], v[26:27]
    v_pk_add_f32 v[12:13], v[12:13], v[20:21]
    v_pk_add_f32 v[14:15], v[14:15], v[22:23]
    v_pk_add_f32 v[8:9], v[8:9], v[16:17]
    v_pk_add_f32 v[10:11], v[10:11], v[18:19]
    v_pk_add_f32 v[8:9], v[8:9], v[12:13]
    v_pk_add_f32 v[10:11], v[10:11], v[14:15]
    v_and_or_b32 v8, v8, v2, s88
    v_and_or_b32 v9, v9, v2, s89
    v_and_or_b32 v10, v10, v2, s90
    v_and_or_b32 v11, v11, v2, s91
    buffer_store_dwordx4 v[8:11], v3, s[64:67], s94 offen sc1
    v_add_u32 v5, 3072, v3
    s_mov_b32 s93, 20000
q_poll:
    buffer_load_dwordx4 v[16:19], v3, s[64:67], s95 offen offset:0 sc1
    buffer_load_dwordx4 v[20:23], v3, s[64:67], s95 offen offset:768 sc1
    buffer_load_dwordx4 v[24:27], v3, s[64:67], s95 offen offset:1536 sc1
    buffer_load_dwordx4 v[28:31], v3, s[64:67], s95 offen offset:2304 sc1
    buffer_load_dwordx4 v[32:35], v5, s[64:67], s95 offen offset:0 sc1
    buffer_load_dwordx4 v[36:39], v5, s[64:67], s95 offen offset:768 sc1
    buffer_load_dwordx4 v[40:43], v5, s[64:67], s95 offen offset:1536 sc1
    buffer_load_dwordx4 v[44:47], v5, s[64:67], s95 offen offset:2304 sc1
    s_waitcnt vmcnt(0)
    v_xor_b32 v8, s88, v16
    v_xor_b32 v9, s89, v17
    v_xor_b32 v10, s90, v18
    v_xor_b32 v11, s91, v19
    v_or3_b32 v8, v8, v9, v10
    v_or_b32 v8, v8, v11
    v_xor_b32 v9, s88, v20
    v_xor_b32 v10, s89, v21
    v_xor_b32 v11, s90, v22
    v_xor_b32 v12, s91, v23
    v_or3_b32 v8, v8, v9, v10
    v_or3_b32 v8, v8, v11, v12
    v_xor_b32 v9, s88, v24
    v_xor_b32 v10, s89, v25
    v_xor_b32 v11, s90, v26
    v_xor_b32 v12, s91, v27
    v_or3_b32 v8, v8, v9, v10
    v_or3_b32 v8, v8, v11, v12
    v_xor_b32 v9, s88, v28
    v_xor_b32 v10, s89, v29
    v_xor_b32 v11, s90, v30
    v_xor_b32 v12, s91, v31
    v_or3_b32 v8, v8, v9, v10
    v_or3_b32 v8, v8, v11, v12
    v_xor_b32 v9, s88, v32
    v_xor_b32 v10, s89, v33
    v_xor_b32 v11, s90, v34
    v_xor_b32 v12, s91, v35
    v_or3_b32 v8, v8, v9, v10
    v_or3_b32 v8, v8, v11, v12
    v_xor_b32 v9, s88, v36
    v_xor_b32 v10, s89, v37
    v_xor_b32 v11, s90, v38
    v_xor_b32 v12, s91, v39
    v_or3_b32 v8, v8, v9, v10
    v_or3_b32 v8, v8, v11, v12
    v_xor_b32 v9, s88, v40
    v_xor_b32 v10, s89, v41
    v_xor_b32 v11, s90, v42
    v_xor_b32 v12, s91, v43
    v_or3_b32 v8, v8, v9, v10
    v_or3_b32 v8, v8, v11, v12
    v_xor_b32 v9, s88, v44
    v_xor_b32 v10, s89, v45
    v_xor_b32 v11, s90, v46
    v_xor_b32 v12, s91, v47
    v_or3_b32 v8, v8, v9, v10
    v_or3_b32 v8, v8, v11, v12
    v_and_b32 v8, 0x7ff, v8
    v_cmp_ne_u32 vcc, 0, v8
    s_cbranch_vccz q_ok
    s_sleep 1
    s_sub_u32 s93, s93, 1
    s_cmp_lg_u32 s93, 0
    s_cbranch_scc1 q_poll
q_ok:
    v_pk_add_f32 v[16:17], v[16:17], v[44:45]
    v_pk_add_f32 v[18:19], v[18:19], v[46:47]
    v_pk_add_f32 v[20:21], v[20:21], v[40:41]
    v_pk_add_f32 v[22:23], v[22:23], v[42:43]
    v_pk_add_f32 v[24:25], v[24:25], v[36:37]
    v_pk_add_f32 v[26:27], v[26:27], v[38:39]
    v_pk_add_f32 v[28:29], v[28:29], v[32:33]
    v_pk_add_f32 v[30:31], v[30:31], v[34:35]
    v_pk_add_f32 v[16:17], v[16:17], v[28:29]
    v_pk_add_f32 v[18:19], v[18:19], v[30:31]
    v_pk_add_f32 v[20:21], v[20:21], v[24:25]
    v_pk_add_f32 v[22:23], v[22:23], v[26:27]
    v_pk_add_f32 v[16:17], v[16:17], v[20:21]
    v_pk_add_f32 v[18:19], v[18:19], v[22:23]
    v_cvt_pk_bf16_f32 v16, v16, v17
    v_cvt_pk_bf16_f32 v17, v18, v19
    v_lshlrev_b32 v5, 3, v1
    ds_write_b64 v5, v[16:17] offset:16896
    s_waitcnt lgkmcnt(0)
    s_barrier
    s_mov_b64 exec, -1
    v_and_b32 v5, 7, v1
    v_lshlrev_b32 v5, 3, v5
    s_mov_b32 s93, 80000
L_ml_poll:
    ds_read_b64 v[8:9], v5 offset:17408
    s_waitcnt lgkmcnt(0)
    v_cmp_eq_u32 vcc, 0, v9
    s_cbranch_vccz L_ml_ok
    s_sleep 4
    s_sub_u32 s93, s93, 1
    s_cmp_lg_u32 s93, 0
    s_cbranch_scc1 L_ml_poll
L_ml_ok:
    v_mov_b32 v12, v8
    s_nop 1
    v_max_f32_dpp v12, v12, v12 quad_perm:[1,0,3,2] row_mask:0xf bank_mask:0xf
    s_nop 1
    v_max_f32_dpp v12, v12, v12 quad_perm:[2,3,0,1] row_mask:0xf bank_mask:0xf
    s_nop 1
    v_max_f32_dpp v12, v12, v12 row_half_mirror row_mask:0xf bank_mask:0xf
    v_sub_f32 v10, v8, v12
    v_mul_f32 v10, 0x3fb8aa3b, v10
    v_exp_f32 v10, v10
    s_nop 0
    v_mul_f32 v13, v10, v9
    s_nop 1
    v_add_f32_dpp v13, v13, v13 quad_perm:[1,0,3,2] row_mask:0xf bank_mask:0xf
    s_nop 1
    v_add_f32_dpp v13, v13, v13 quad_perm:[2,3,0,1] row_mask:0xf bank_mask:0xf
    s_nop 1
    v_add_f32_dpp v13, v13, v13 row_half_mirror row_mask:0xf bank_mask:0xf
    v_mov_b32 v14, 0
    v_mov_b32 v15, 0
    v_and_or_b32 v12, v12, v2, s88
    v_and_or_b32 v13, v13, v2, s89
    v_and_or_b32 v14, v14, v2, s90
    v_and_or_b32 v15, v15, v2, s91
    s_mov_b64 exec, 1
    buffer_store_dwordx4 v[12:15], v3, s[64:67], s97 offen offset:768 sc1
    s_mov_b64 exec, -1
    v_readlane_b32 s4, v10, 0
    v_readlane_b32 s5, v10, 1
    v_readlane_b32 s6, v10, 2
    v_readlane_b32 s7, v10, 3
    v_readlane_b32 s8, v10, 4
    v_readlane_b32 s9, v10, 5
    v_readlane_b32 s10, v10, 6
    v_readlane_b32 s11, v10, 7
    v_mul_u32_u24 v5, 43, v1
    v_lshrrev_b32 v5, 8, v5
    v_mul_u32_u24 v6, 6, v5
    v_sub_u32 v6, v1, v6
    v_lshlrev_b32 v5, 5, v5
    v_and_b32 v7, 1, v6
    v_lshl_add_u32 v5, v7, 4, v5
    v_lshrrev_b32 v6, 1, v6
    v_lshl_add_u32 v5, v6, 8, v5
    s_mov_b32 exec_hi, 0xffff
    s_barrier
    ds_read_b128 v[16:19], v3 offset:17920
    ds_read_b128 v[20:23], v3 offset:18688
    ds_read_b128 v[24:27], v3 offset:19456
    ds_read_b128 v[28:31], v3 offset:20224
    ds_read_b128 v[32:35], v3 offset:20992
    ds_read_b128 v[36:39], v3 offset:21760
    ds_read_b128 v[40:43], v3 offset:22528
    ds_read_b128 v[44:47], v3 offset:23296
    s_waitcnt lgkmcnt(0)
    v_mul_f32 v8, s4, v16
    v_mul_f32 v9, s4, v17
    v_mul_f32 v10, s4, v18
    v_mul_f32 v11, s4, v19
    v_fmac_f32 v8, s5, v20
    v_fmac_f32 v9, s5, v21
    v_fmac_f32 v10, s5, v22
    v_fmac_f32 v11, s5, v23
    v_fmac_f32 v8, s6, v24
    v_fmac_f32 v9, s6, v25
    v_fmac_f32 v10, s6, v26
    v_fmac_f32 v11, s6, v27
    v_fmac_f32 v8, s7, v28
    v_fmac_f32 v9, s7, v29
    v_fmac_f32 v10, s7, v30
    v_fmac_f32 v11, s7, v31
    v_mul_f32 v12, s8, v32
    v_mul_f32 v13, s8, v33
    v_mul_f32 v14, s8, v34
    v_mul_f32 v15, s8, v35
    v_fmac_f32 v12, s9, v36
    v_fmac_f32 v13, s9, v37
    v_fmac_f32 v14, s9, v38
    v_fmac_f32 v15, s9, v39
    v_fmac_f32 v12, s10, v40
    v_fmac_f32 v13, s10, v41
    v_fmac_f32 v14, s10, v42
    v_fmac_f32 v15, s10, v43
    v_fmac_f32 v12, s11, v44
    v_fmac_f32 v13, s11, v45
    v_fmac_f32 v14, s11, v46
    v_fmac_f32 v15, s11, v47
    v_add_f32 v8, v8, v12
    v_add_f32 v9, v9, v13
    v_add_f32 v10, v10, v14
    v_add_f32 v11, v11, v15
    v_and_or_b32 v8, v8, v2, s88
    v_and_or_b32 v9, v9, v2, s89
    v_and_or_b32 v10, v10, v2, s90
    v_and_or_b32 v11, v11, v2, s91
    buffer_store_dwordx4 v[8:11], v5, s[64:67], s97 offen sc1
    s_cmp_ge_u32 s2, 240
    s_cbranch_scc1 L_owner
    s_mov_b64 exec, 0xffff
    s_mul_i32 s94, s15, 24
    s_add_u32 s94, s94, s14
    s_lshl_b32 s94, s94, 8
    s_add_u32 s94, s94, 655360
    s_barrier
    ds_read_b128 v[16:19], v3 offset:24064
    ds_read_b128 v[20:23], v3 offset:24320
    ds_read_b128 v[24:27], v3 offset:24576
    ds_read_b128 v[28:31], v3 offset:24832
    ds_read_b128 v[32:35], v3 offset:25088
    ds_read_b128 v[36:39], v3 offset:25344
    ds_read_b128 v[40:43], v3 offset:25600
    ds_read_b128 v[44:47], v3 offset:25856
    s_waitcnt lgkmcnt(0)
    v_pk_add_f32 v[16:17], v[16:17], v[44:45]
    v_pk_add_f32 v[18:19], v[18:19], v[46:47]
    v_pk_add_f32 v[20:21], v[20:21], v[40:41]
    v_pk_add_f32 v[22:23], v[22:23], v[42:43]
    v_pk_add_f32 v[24:25], v[24:25], v[36:37]
    v_pk_add_f32 v[26:27], v[26:27], v[38:39]
    v_pk_add_f32 v[28:29], v[28:29], v[32:33]
    v_pk_add_f32 v[30:31], v[30:31], v[34:35]
    v_pk_add_f32 v[16:17], v[16:17], v[28:29]
    v_pk_add_f32 v[18:19], v[18:19], v[30:31]
    v_pk_add_f32 v[20:21], v[20:21], v[24:25]
    v_pk_add_f32 v[22:23], v[22:23], v[26:27]
    v_pk_add_f32 v[16:17], v[16:17], v[20:21]
    v_pk_add_f32 v[18:19], v[18:19], v[22:23]
    v_and_or_b32 v16, v16, v2, s88
    v_and_or_b32 v17, v17, v2, s89
    v_and_or_b32 v18, v18, v2, s90
    v_and_or_b32 v19, v19, v2, s91
    buffer_store_dwordx4 v[16:19], v3, s[64:67], s94 offen sc1
    s_cmp_lt_u32 s2, 214
    s_cbranch_scc1 L_final
    s_cmp_lt_u32 s2, 236
    s_cbranch_scc1 L_comm_end
L_owner:
    s_mov_b64 exec, -1
    s_sub_u32 s94, s2, 236
    s_lshr_b32 s95, s94, 1
    s_mul_i32 s95, s95, 6144
    s_and_b32 s96, s94, 1
    s_lshl_b32 s96, s96, 7
    s_add_u32 s95, s95, s96
    s_add_u32 s95, s95, 655360
    s_lshl_b32 s94, s94, 7
    s_add_u32 s94, s94, 720896
    v_lshrrev_b32 v5, 3, v1
    v_lshlrev_b32 v5, 8, v5
    v_and_b32 v6, 7, v1
    v_lshl_add_u32 v5, v6, 4, v5
    v_add_u32 v6, 4096, v5
    s_sub_u32 s96, s2, 236
    s_mul_i32 s96, s96, 128
    s_add_u32 s96, s96, 733184
    v_lshrrev_b32 v7, 2, v1
    v_mul_u32_u24 v7, 2560, v7
    v_and_b32 v4, 48, v3
    v_add_u32 v7, v7, v4
    v_add_u32 v7, s96, v7
    v_add_u32 v4, s94, v3
    v_cmp_gt_u32 s[4:5], 32, v1
    s_nop 1
    v_cndmask_b32 v7, v7, v4, s[4:5]
    v_lshlrev_b32 v16, 16, v160
    v_and_b32 v17, 0xffff0000, v160
    v_lshlrev_b32 v18, 16, v161
    v_and_b32 v19, 0xffff0000, v161
    s_mov_b32 s93, 20000
    buffer_load_dwordx4 v[24:27], v5, s[64:67], s95 offen sc1
    buffer_load_dwordx4 v[28:31], v5, s[64:67], s95 offen offset:2048 sc1
    buffer_load_dwordx4 v[32:35], v6, s[64:67], s95 offen sc1
    s_sleep 3
    buffer_load_dwordx4 v[24:27], v5, s[64:67], s95 offen sc1
    buffer_load_dwordx4 v[28:31], v5, s[64:67], s95 offen offset:2048 sc1
    buffer_load_dwordx4 v[32:35], v6, s[64:67], s95 offen sc1
    s_sleep 3
y_poll:
    buffer_load_dwordx4 v[24:27], v5, s[64:67], s95 offen sc1
    buffer_load_dwordx4 v[28:31], v5, s[64:67], s95 offen offset:2048 sc1
    buffer_load_dwordx4 v[32:35], v6, s[64:67], s95 offen sc1
    s_waitcnt vmcnt(6)
    v_xor_b32 v8, s88, v24
    v_xor_b32 v9, s89, v25
    v_xor_b32 v10, s90, v26
    v_xor_b32 v11, s91, v27
    v_or3_b32 v8, v8, v9, v10
    v_or_b32 v8, v8, v11
    v_xor_b32 v9, s88, v28
    v_xor_b32 v10, s89, v29
    v_xor_b32 v11, s90, v30
    v_xor_b32 v12, s91, v31
    v_or3_b32 v8, v8, v9, v10
    v_or3_b32 v8, v8, v11, v12
    v_xor_b32 v9, s88, v32
    v_xor_b32 v10, s89, v33
    v_xor_b32 v11, s90, v34
    v_xor_b32 v12, s91, v35
    v_or3_b32 v8, v8, v9, v10
    v_or3_b32 v8, v8, v11, v12
    v_and_b32 v8, 0x7ff, v8
    v_cmp_ne_u32 vcc, 0, v8
    s_cbranch_vccz y_ok
    s_mov_b64 exec, vcc
    s_sub_u32 s93, s93, 1
    s_cmp_lg_u32 s93, 0
    s_cbranch_scc1 y_poll
y_ok:
    s_mov_b64 exec, -1
    v_pk_add_f32 v[40:41], v[24:25], v[28:29]
    v_pk_add_f32 v[42:43], v[26:27], v[30:31]
    v_pk_add_f32 v[40:41], v[40:41], v[32:33]
    v_pk_add_f32 v[42:43], v[42:43], v[34:35]
    s_nop 0
    v_add_f32_dpp v40, v40, v40 row_ror:8 row_mask:0xf bank_mask:0xf
    v_add_f32_dpp v41, v41, v41 row_ror:8 row_mask:0xf bank_mask:0xf
    v_add_f32_dpp v42, v42, v42 row_ror:8 row_mask:0xf bank_mask:0xf
    v_add_f32_dpp v43, v43, v43 row_ror:8 row_mask:0xf bank_mask:0xf
    v_mov_b32 v8, v40
    v_mov_b32 v9, v41
    v_mov_b32 v10, v42
    v_mov_b32 v11, v43
    v_permlane16_swap_b32 v40, v8
    v_permlane16_swap_b32 v41, v9
    v_permlane16_swap_b32 v42, v10
    v_permlane16_swap_b32 v43, v11
    v_add_f32 v40, v40, v8
    v_add_f32 v41, v41, v9
    v_add_f32 v42, v42, v10
    v_add_f32 v43, v43, v11
    v_mov_b32 v8, v40
    v_mov_b32 v9, v41
    v_mov_b32 v10, v42
    v_mov_b32 v11, v43
    v_permlane32_swap_b32 v40, v8
    v_permlane32_swap_b32 v41, v9
    v_permlane32_swap_b32 v42, v10
    v_permlane32_swap_b32 v43, v11
    v_add_f32 v40, v40, v8
    v_add_f32 v41, v41, v9
    v_add_f32 v42, v42, v10
    v_add_f32 v43, v43, v11
    v_cvt_pk_bf16_f32 v40, 0, v40
    v_cvt_pk_bf16_f32 v41, 0, v41
    v_cvt_pk_bf16_f32 v42, 0, v42
    v_cvt_pk_bf16_f32 v43, 0, v43
    v_pk_add_f32 v[40:41], v[40:41], v[16:17]
    v_pk_add_f32 v[42:43], v[42:43], v[18:19]
    v_cvt_pk_bf16_f32 v40, 0, v40
    v_cvt_pk_bf16_f32 v41, 0, v41
    v_cvt_pk_bf16_f32 v42, 0, v42
    v_cvt_pk_bf16_f32 v43, 0, v43
    v_pk_add_f32 v[8:9], v[40:41], v[42:43]
    v_pk_mul_f32 v[10:11], v[40:41], v[40:41]
    v_pk_fma_f32 v[10:11], v[42:43], v[42:43], v[10:11]
    v_add_f32 v8, v8, v9
    v_add_f32 v10, v10, v11
    s_nop 0
    v_add_f32_dpp v8, v8, v8 quad_perm:[1,0,3,2] row_mask:0xf bank_mask:0xf
    v_add_f32_dpp v10, v10, v10 quad_perm:[1,0,3,2] row_mask:0xf bank_mask:0xf
    s_nop 0
    v_add_f32_dpp v8, v8, v8 quad_perm:[2,3,0,1] row_mask:0xf bank_mask:0xf
    v_add_f32_dpp v10, v10, v10 quad_perm:[2,3,0,1] row_mask:0xf bank_mask:0xf
    s_nop 0
    v_add_f32_dpp v8, v8, v8 row_half_mirror row_mask:0xf bank_mask:0xf
    v_add_f32_dpp v10, v10, v10 row_half_mirror row_mask:0xf bank_mask:0xf
    v_lshlrev_b32 v9, 21, v8
    v_lshlrev_b32 v11, 21, v10
    v_cndmask_b32 v40, v8, v40, s[4:5]
    v_cndmask_b32 v41, v9, v41, s[4:5]
    v_cndmask_b32 v42, v10, v42, s[4:5]
    v_cndmask_b32 v43, v11, v43, s[4:5]
    s_and_b32 exec_lo, exec_lo, 0xff
    v_and_or_b32 v40, v40, v2, s88
    v_and_or_b32 v41, v41, v2, s89
    v_and_or_b32 v42, v42, v2, s90
    v_and_or_b32 v43, v43, v2, s91
    buffer_store_dwordx4 v[40:43], v7, s[64:67], 0 offen sc1
    s_branch L_comm_end
L_final:
    s_mov_b64 exec, -1
    s_and_b32 s94, s2, 7
    s_mul_i32 s94, s94, 2560
    s_add_u32 s94, s94, 753664
    v_mul_u32_u24 v5, 128, v1
    v_add_u32 v5, s94, v5
    s_mul_i32 s95, s2, 12
    s_and_b32 s95, s95, -16
    s_add_u32 s95, s95, 720576
    v_add_u32 v6, s95, v3
    v_min_u32 v6, 723440, v6
    v_cmp_gt_u32 s[4:5], 20, v1
    s_nop 1
    v_cndmask_b32 v5, v6, v5, s[4:5]
    v_cndmask_b32 v6, 0, v2, s[4:5]
    v_cndmask_b32 v7, 0, 11, s[4:5]
    s_mov_b64 exec, 0x3fffff
    s_mov_b32 s93, 20000
    buffer_load_dwordx4 v[24:27], v5, s[64:67], 0 offen sc1
    s_sleep 3
h_poll:
    buffer_load_dwordx4 v[24:27], v5, s[64:67], 0 offen sc1
    s_waitcnt vmcnt(1)
    v_xor_b32 v8, s88, v24
    v_xor_b32 v9, s89, v25
    v_xor_b32 v10, s90, v26
    v_xor_b32 v11, s91, v27
    v_or3_b32 v8, v8, v9, v10
    v_or_b32 v8, v8, v11
    v_and_b32 v8, 0x7ff, v8
    v_cmp_ne_u32 vcc, 0, v8
    s_cbranch_vccz h_ok
    s_mov_b64 exec, vcc
    s_sub_u32 s93, s93, 1
    s_cmp_lg_u32 s93, 0
    s_cbranch_scc1 h_poll
h_ok:
    s_mov_b64 exec, -1
    v_bfe_u32 v8, v25, 21, v7
    v_bfe_u32 v9, v27, 21, v7
    v_and_or_b32 v8, v24, v6, v8
    v_and_or_b32 v9, v26, v6, v9
    v_and_b32 v40, 0xffff0000, v24
    v_and_b32 v41, 0xffff0000, v25
    v_and_b32 v42, 0xffff0000, v26
    v_and_b32 v43, 0xffff0000, v27
    v_add_f32_dpp v8, v8, v8 quad_perm:[1,0,3,2] row_mask:0xf bank_mask:0xf
    v_add_f32_dpp v9, v9, v9 quad_perm:[1,0,3,2] row_mask:0xf bank_mask:0xf
    s_nop 0
    v_add_f32_dpp v8, v8, v8 quad_perm:[2,3,0,1] row_mask:0xf bank_mask:0xf
    v_add_f32_dpp v9, v9, v9 quad_perm:[2,3,0,1] row_mask:0xf bank_mask:0xf
    s_nop 0
    v_add_f32_dpp v8, v8, v8 row_half_mirror row_mask:0xf bank_mask:0xf
    v_add_f32_dpp v9, v9, v9 row_half_mirror row_mask:0xf bank_mask:0xf
    s_nop 0
    v_add_f32_dpp v8, v8, v8 row_ror:8 row_mask:0xf bank_mask:0xf
    v_add_f32_dpp v9, v9, v9 row_ror:8 row_mask:0xf bank_mask:0xf
    v_mov_b32 v10, v8
    v_mov_b32 v11, v9
    s_nop 0
    v_permlane16_swap_b32 v8, v10
    v_permlane16_swap_b32 v9, v11
    v_add_f32 v8, v8, v10
    v_add_f32 v9, v9, v11
    v_mul_f32 v8, 0x3acccccd, v8
    v_mul_f32 v9, 0x3acccccd, v9
    v_fma_f32 v9, -v8, v8, v9
    v_max_f32 v9, 0, v9
    v_cvt_pk_bf16_f32 v10, 0, v9
    v_add_f32 v10, 0x3727c5ac, v10
    v_cvt_pk_bf16_f32 v10, 0, v10
    v_sqrt_f32 v10, v10
    v_cvt_pk_bf16_f32 v12, 0, v8
    v_cvt_pk_bf16_f32 v10, 0, v10
    v_rcp_f32 v10, v10
    v_sub_f32 v8, v8, v12
    v_mul_f32 v9, v9, v10
    v_mul_f32 v9, v9, v10
    v_cvt_pk_bf16_f32 v9, 0, v9
    v_add_f32 v9, 0x3727c5ac, v9
    v_cvt_pk_bf16_f32 v9, 0, v9
    v_sqrt_f32 v9, v9
    v_mul_f32 v8, v8, v10
    v_cvt_pk_bf16_f32 v9, 0, v9
    v_rcp_f32 v11, v9
    v_cvt_pk_bf16_f32 v13, 0, v8
    v_pk_add_f32 v[44:45], v[40:41], v[12:13] op_sel:[0,0] op_sel_hi:[1,0] neg_lo:[0,1] neg_hi:[0,1]
    v_pk_add_f32 v[46:47], v[42:43], v[12:13] op_sel:[0,0] op_sel_hi:[1,0] neg_lo:[0,1] neg_hi:[0,1]
    v_cvt_pk_bf16_f32 v44, 0, v44
    v_cvt_pk_bf16_f32 v45, 0, v45
    v_cvt_pk_bf16_f32 v46, 0, v46
    v_cvt_pk_bf16_f32 v47, 0, v47
    v_pk_mul_f32 v[44:45], v[44:45], v[10:11] op_sel:[0,0] op_sel_hi:[1,0]
    v_pk_mul_f32 v[46:47], v[46:47], v[10:11] op_sel:[0,0] op_sel_hi:[1,0]
    v_cvt_pk_bf16_f32 v44, 0, v44
    v_cvt_pk_bf16_f32 v45, 0, v45
    v_cvt_pk_bf16_f32 v46, 0, v46
    v_cvt_pk_bf16_f32 v47, 0, v47
    v_pk_add_f32 v[44:45], v[44:45], v[12:13] op_sel:[0,1] op_sel_hi:[1,1] neg_lo:[0,1] neg_hi:[0,1]
    v_pk_add_f32 v[46:47], v[46:47], v[12:13] op_sel:[0,1] op_sel_hi:[1,1] neg_lo:[0,1] neg_hi:[0,1]
    v_cvt_pk_bf16_f32 v44, 0, v44
    v_cvt_pk_bf16_f32 v45, 0, v45
    v_cvt_pk_bf16_f32 v46, 0, v46
    v_cvt_pk_bf16_f32 v47, 0, v47
    v_pk_mul_f32 v[44:45], v[44:45], v[10:11] op_sel:[0,1] op_sel_hi:[1,1]
    v_pk_mul_f32 v[46:47], v[46:47], v[10:11] op_sel:[0,1] op_sel_hi:[1,1]
    v_cvt_pk_bf16_f32 v44, 0, v44
    v_cvt_pk_bf16_f32 v45, 0, v45
    v_cvt_pk_bf16_f32 v46, 0, v46
    v_cvt_pk_bf16_f32 v47, 0, v47
    s_and_b64 exec, exec, 0x300000
    ds_write_b128 v3, v[44:47] offset:25792
    s_waitcnt lgkmcnt(0)
    s_barrier
    ds_write_b128 v3, v[40:43] offset:28608
    s_cmp_lg_u32 s2, 0
    s_cbranch_scc1 L_noep
    s_add_u32 s94, s92, 1
    s_mov_b64 exec, 1
    v_mov_b32 v8, s94
    buffer_store_dword v8, v3, s[64:67], 0 offen
L_noep:
    s_mov_b64 exec, 7
    s_mul_i32 s94, s2, 3
    v_add_u32 v6, s94, v1
    s_and_b32 s94, s94, 3
    v_add_lshl_u32 v7, v1, s94, 2
    ds_read_b32 v20, v7 offset:28928
    v_lshlrev_b32 v6, 1, v6
    v_lshlrev_b32 v5, 5, v1
    v_lshlrev_b32 v162, 16, v162
    s_barrier
    ds_read_b128 v[8:11], v5 offset:31744
    ds_read_b128 v[12:15], v5 offset:31760
    s_waitcnt lgkmcnt(0)
    v_pk_add_f32 v[8:9], v[8:9], v[12:13]
    v_pk_add_f32 v[10:11], v[10:11], v[14:15]
    v_pk_add_f32 v[8:9], v[8:9], v[10:11]
    v_add_f32 v8, v8, v9
    v_cvt_pk_bf16_f32 v8, 0, v8
    v_add_f32 v8, v8, v162
    v_cvt_pk_bf16_f32 v8, 0, v8
    v_add_f32 v8, v8, v20
    v_cvt_pk_bf16_f32 v8, v8, 0
    buffer_store_short v8, v6, s[80:83], 0 offen
L_comm_end:
L_end:
    s_endpgm
.section .rodata,"a"
.p2align 6
.amdhsa_kernel sequential_preLN__sliding_block_cached__mixer_token_mlp__decode_kernel
  .amdhsa_next_free_vgpr 168
  .amdhsa_next_free_sgpr 102
  .amdhsa_accum_offset 168
  .amdhsa_group_segment_fixed_size 0
  .amdhsa_kernarg_size 104
  .amdhsa_user_sgpr_count 2
  .amdhsa_user_sgpr_kernarg_segment_ptr 1
  .amdhsa_system_sgpr_workgroup_id_x 1
.end_amdhsa_kernel
```
